```python
import torch

def _softmax(x, axis=-1):
    return torch.softmax(x, dim=axis)
def _gelu(x):
    return torch.nn.functional.gelu(x, approximate="tanh")
def _silu(x):
    return torch.nn.functional.silu(x)
def _sigmoid(x):
    return torch.sigmoid(x)
def _layernorm(x, axis=-1, eps=1e-5):
    m = x.mean(dim=axis, keepdim=True)
    v = x.var(dim=axis, keepdim=True, unbiased=False)
    return (x - m) / torch.sqrt(v + eps)
def _scatter_add(tgt, idx, src, axis=0):
    return tgt.clone().index_add_(axis, idx, src)
def _segment_sum(src, seg, n):
    out = torch.zeros((n,) + src.shape[1:], dtype=src.dtype)
    return out.index_add_(0, seg, src)
def _pad(x, pw):
    flat = tuple(v for pair in reversed(pw) for v in pair)
    return torch.nn.functional.pad(x, flat)

kernel_name = 'parallel_sum__sliding_block__dense_activation_gelu__prompt'

def setup_inputs():

    _w = (lambda a: (lambda t: t.to(torch.bfloat16) if t.is_floating_point() else t)(torch.as_tensor(a)))
    def _A_setup():
        B, S, D = 1, 2048, 640
        return {
            "x": _w((lambda *s: torch.randn(*s, dtype=torch.bfloat16) * 0.05)(B, S, D)),
            "wqkv": _w((lambda *s: torch.randn(*s, dtype=torch.bfloat16) * 0.05)(D, 3 * D)),
            "wo": _w((lambda *s: torch.randn(*s, dtype=torch.bfloat16) * 0.05)(D, D)),
        }
    _A_in = _A_setup()

    def _B_setup():
        B, S, D, F = 1, 2048, 640, 1536
        return {
            "x": _w((lambda *s: torch.randn(*s, dtype=torch.bfloat16) * 0.05)(B, S, D)),
            "w1": _w((lambda *s: torch.randn(*s, dtype=torch.bfloat16) * 0.8)(D, F) * (D ** -0.5)),
            "b1": _w((lambda *s: torch.randn(*s, dtype=torch.bfloat16) * 0.8)(F) * 0.01),
            "w2": _w((lambda *s: torch.randn(*s, dtype=torch.bfloat16) * 0.8)(F, D) * (F ** -0.5)),
            "b2": _w((lambda *s: torch.randn(*s, dtype=torch.bfloat16) * 0.8)(D) * 0.01),
        }
    _B_in = _B_setup()

    return {
        "A_x": _A_in["x"],
        "A_wqkv": _A_in["wqkv"],
        "A_wo": _A_in["wo"],
        "B_x": _B_in["x"],
        "B_w1": _B_in["w1"],
        "B_b1": _B_in["b1"],
        "B_w2": _B_in["w2"],
        "B_b2": _B_in["b2"],
    }

def reference(A_x, A_wqkv, A_wo, B_x, B_w1, B_b1, B_w2, B_b2):
    def _A_ref(x, wqkv, wo):
        B, S, D = x.shape
        H = 32; Dh = D // H; W = 256
        qkv = (lambda x, *d: x.permute(*d))((x @ wqkv).reshape(B, S, 3, H, Dh), 2, 0, 3, 1, 4)
        q, k, v = qkv[0], qkv[1], qkv[2]
        scores = torch.einsum("bhqd,bhkd->bhqk", q, k) * (Dh ** -0.5)
        idx = torch.arange(S)
        mask = (idx[:, None] - idx[None, :] >= 0) & (idx[:, None] - idx[None, :] < W)
        scores = torch.where(mask[None, None], scores, -1e9)
        p = _softmax(scores, axis=-1)
        o = torch.einsum("bhqk,bhkd->bhqd", p, v)
        return (lambda x, *d: x.permute(*d))(o, 0, 2, 1, 3).reshape(B, S, D) @ wo

    def _B_ref(x, w1, b1, w2, b2):
        h = torch.einsum("bsd,df->bsf", x, w1) + b1
        h = _gelu(h)
        return torch.einsum("bsf,fd->bsd", h, w2) + b2

    x = A_x
    xn = _layernorm(x, axis=-1)
    return x + _A_ref(xn, A_wqkv, A_wo) + _B_ref(xn, B_w1, B_b1, B_w2, B_b2)
```

```asm
; @launch grid=(256,1,1) block=(512,1,1) lds=163520
.amdgcn_target "amdgcn-amd-amdhsa--gfx950"
.text
.globl parallel_sum__sliding_block__dense_activation_gelu__prompt_kernel
.p2align 8
.type parallel_sum__sliding_block__dense_activation_gelu__prompt_kernel,@function
parallel_sum__sliding_block__dense_activation_gelu__prompt_kernel:
    s_cmp_ge_u32 s2, 256
    s_cbranch_scc1 parallel_sum__sliding_block__dense_activation_gelu__prompt_kernel_end
    s_load_dwordx4 s[32:35], s[0:1], 0
    s_load_dwordx4 s[36:39], s[0:1], 32
    s_load_dwordx4 s[60:63], s[0:1], 72
    s_load_dwordx2 s[72:73], s[0:1], 16
    s_load_dwordx4 s[96:99], s[0:1], 48
    s_load_dwordx2 s[100:101], s[0:1], 64
    v_lshrrev_b32 v1, 6, v0
    s_and_b32 s6, s2, 7
    s_lshr_b32 s7, s2, 3
    v_readfirstlane_b32 s3, v1
    s_and_b32 s4, s6, 1
    s_lshl_b32 s4, s4, 3
    s_and_b32 s40, s7, 7
    s_add_u32 s4, s4, s40
    s_lshr_b32 s5, s6, 1
    s_lshl_b32 s5, s5, 2
    s_lshr_b32 s40, s7, 3
    s_add_u32 s5, s5, s40
    v_and_b32 v0, 63, v0
    s_mov_b32 s51, 4294868992
    s_cmp_ge_u32 s3, 4
    s_cbranch_scc0 parallel_sum__sliding_block__dense_activation_gelu__prompt_kernel_compute
    s_sub_u32 s57, s3, 4
    v_lshrrev_b32 v3, 3, v0
    v_mul_u32_u24 v3, 1280, v3
    v_lshrrev_b32 v4, 4, v0
    v_and_b32 v5, 7, v0
    v_xor_b32 v6, v5, v4
    v_lshl_add_u32 v1, v6, 4, v3
    v_xor_b32 v6, 4, v6
    v_lshl_add_u32 v2, v6, 4, v3
    v_bfe_u32 v8, v0, 2, 2
    v_xor_b32 v8, v8, v4
    v_and_b32 v9, 3, v0
    v_lshl_add_u32 v8, v8, 2, v9
    v_mul_u32_u24 v10, 3840, v4
    v_lshl_add_u32 v7, v8, 4, v10
    s_lshl_b32 s7, s5, 8
    s_cmp_eq_u32 s5, 15
    s_cselect_b32 s7, 0x40000000, s7
    v_add_u32 v7, s7, v7
    s_mul_i32 s7, s5, 192
    v_add_u32 v14, 0, v0
    v_mul_u32_u24 v15, 171, v14
    v_lshrrev_b32 v15, 11, v15
    v_mul_u32_u24 v16, 12, v15
    v_sub_u32 v16, v14, v16
    v_mul_u32_u24 v15, 3072, v15
    v_lshl_add_u32 v15, v16, 4, v15
    v_add_u32 v11, s7, v15
    v_add_u32 v14, 64, v0
    v_mul_u32_u24 v15, 171, v14
    v_lshrrev_b32 v15, 11, v15
    v_mul_u32_u24 v16, 12, v15
    v_sub_u32 v16, v14, v16
    v_mul_u32_u24 v15, 3072, v15
    v_lshl_add_u32 v15, v16, 4, v15
    v_add_u32 v12, s7, v15
    v_add_u32 v14, 128, v0
    v_mul_u32_u24 v15, 171, v14
    v_lshrrev_b32 v15, 11, v15
    v_mul_u32_u24 v16, 12, v15
    v_sub_u32 v16, v14, v16
    v_mul_u32_u24 v15, 3072, v15
    v_lshl_add_u32 v15, v16, 4, v15
    v_add_u32 v13, s7, v15
    s_add_u32 s48, s4, s5
    s_cmp_ge_u32 s48, 20
    s_cselect_b32 s7, 20, 0
    s_sub_u32 s48, s48, s7
    s_cmp_ge_u32 s48, 10
    s_cselect_b32 s7, 10, 0
    s_sub_u32 s48, s48, s7
    s_lshl_b32 s7, s4, 7
    s_lshl_b32 s6, s57, 5
    s_add_u32 s7, s7, s6
    s_mul_i32 s40, s7, 1280
    s_lshl_b32 s7, s48, 7
    s_add_u32 s40, s40, s7
    s_lshl_b32 s7, s48, 6
    s_lshl_b32 s6, s57, 4
    s_add_u32 s7, s7, s6
    s_mul_i32 s41, s7, 3840
    s_mul_i32 s42, s7, 3072
    s_lshl_b32 s43, s57, 12
    s_add_u32 s43, s43, 32768
    s_add_u32 s44, s43, 16384
    s_mul_i32 s45, s57, 3072
    s_add_u32 s45, s45, 49152
    s_mov_b32 s50, 1
    s_mov_b32 s58, 4294966144
    s_mov_b32 s59, 4292755456
    s_mov_b32 s49, 4293197824
    v_add_u32 v100, 0, v1
    v_add_u32 v104, 0, v7
    v_add_u32 v101, 9216, v2
    v_add_u32 v105, 14336, v7
    v_add_u32 v102, 18432, v1
    v_add_u32 v106, 28672, v7
    v_add_u32 v103, 27648, v2
    v_add_u32 v107, 43008, v7
    v_subrev_u32 v108, 0, v11
    v_subrev_u32 v109, 1024, v12
    v_subrev_u32 v110, 2048, v13
    s_waitcnt lgkmcnt(0)
    s_mov_b32 s8, s32
    s_and_b32 s9, s33, 0xffff
    s_mov_b32 s10, 2621440
    s_mov_b32 s11, 0x20000
    s_mov_b32 s12, s34
    s_and_b32 s13, s35, 0xffff
    s_mov_b32 s14, 2457600
    s_mov_b32 s15, 0x20000
    s_mov_b32 m0, s43
    s_add_u32 s48, s48, 1
    buffer_load_dwordx4 v100, s[8:11], s40 offen offset:0 lds
    s_cmp_eq_u32 s48, 10
    s_cselect_b32 s48, 0, s48
    s_cselect_b32 s35, s58, 128
    s_cselect_b32 s34, s59, 245760
    buffer_load_dwordx4 v101, s[8:11], s40 offen offset:1024 lds
    s_add_u32 s50, s50, 1
    s_cmp_eq_u32 s50, 4
    s_cselect_b32 s32, s51, 32768
    s_cselect_b32 s50, 0, s50
    buffer_load_dwordx4 v102, s[8:11], s40 offen offset:2048 lds
    s_add_u32 s43, s43, s32
    buffer_load_dwordx4 v103, s[8:11], s40 offen offset:3072 lds
    s_mov_b32 m0, s44
    s_add_u32 s40, s40, s35
    buffer_load_dwordx4 v104, s[12:15], s41 offen offset:0 lds
    buffer_load_dwordx4 v105, s[12:15], s41 offen offset:1024 lds
    buffer_load_dwordx4 v106, s[12:15], s41 offen offset:2048 lds
    buffer_load_dwordx4 v107, s[12:15], s41 offen offset:3072 lds
    s_add_u32 s41, s41, s34
    s_add_u32 s44, s44, s32
    s_add_u32 s45, s45, s32
    s_mov_b32 s16, s36
    s_and_b32 s17, s37, 0xffff
    s_mov_b32 s18, 1966080
    s_mov_b32 s19, 0x20000
    s_mov_b32 s24, s38
    s_and_b32 s25, s39, 0xffff
    s_mov_b32 s26, 3072
    s_mov_b32 s27, 0x20000
    s_mov_b32 s28, s60
    s_and_b32 s29, s61, 0xffff
    s_mov_b32 s30, 256
    s_mov_b32 s31, 0x20000
    s_mov_b32 s20, s62
    s_and_b32 s21, s63, 0xffff
    s_mov_b32 s22, 19922944
    s_mov_b32 s23, 0x20000
    s_mov_b32 s64, s72
    s_and_b32 s65, s73, 0xffff
    s_mov_b32 s66, 819200
    s_mov_b32 s67, 0x20000
    s_mov_b32 s68, s96
    s_and_b32 s69, s97, 0xffff
    s_mov_b32 s70, 1966080
    s_mov_b32 s71, 0x20000
    v_mov_b32 v17, 0
    buffer_load_dword v18, v17, s[28:31], 0 offen sc1
    s_cmp_lg_u32 s57, 0
    s_cbranch_scc1 parallel_sum__sliding_block__dense_activation_gelu__prompt_kernel_nobias
    s_mul_i32 s7, s5, 192
    v_lshlrev_b32 v34, 2, v0
    v_add_u32 v34, s7, v34
    buffer_load_dword v35, v34, s[24:27], 0 offen
parallel_sum__sliding_block__dense_activation_gelu__prompt_kernel_nobias:
    s_mov_b32 m0, s43
    s_add_u32 s48, s48, 1
    buffer_load_dwordx4 v100, s[8:11], s40 offen offset:0 lds
    s_cmp_eq_u32 s48, 10
    s_cselect_b32 s48, 0, s48
    s_cselect_b32 s35, s58, 128
    s_cselect_b32 s34, s59, 245760
    buffer_load_dwordx4 v101, s[8:11], s40 offen offset:1024 lds
    s_add_u32 s50, s50, 1
    s_cmp_eq_u32 s50, 4
    s_cselect_b32 s32, s51, 32768
    s_cselect_b32 s50, 0, s50
    buffer_load_dwordx4 v102, s[8:11], s40 offen offset:2048 lds
    s_add_u32 s43, s43, s32
    buffer_load_dwordx4 v103, s[8:11], s40 offen offset:3072 lds
    s_mov_b32 m0, s44
    s_add_u32 s40, s40, s35
    buffer_load_dwordx4 v104, s[12:15], s41 offen offset:0 lds
    buffer_load_dwordx4 v105, s[12:15], s41 offen offset:1024 lds
    buffer_load_dwordx4 v106, s[12:15], s41 offen offset:2048 lds
    buffer_load_dwordx4 v107, s[12:15], s41 offen offset:3072 lds
    s_add_u32 s41, s41, s34
    s_add_u32 s44, s44, s32
    s_add_u32 s45, s45, s32
    s_lshl_b32 s6, s57, 5
    v_and_b32 v30, 31, v0
    v_add_u32 v30, s6, v30
    v_bfe_u32 v31, v30, 1, 3
    v_lshrrev_b32 v32, 5, v0
    v_xor_b32 v31, v31, v32
    v_lshlrev_b32 v30, 7, v30
    v_lshl_add_u32 v20, v31, 4, v30
    v_xor_b32 v21, 32, v20
    v_xor_b32 v22, 64, v20
    v_xor_b32 v23, 96, v20
    v_add_u32 v20, 32768, v20
    v_add_u32 v21, 32768, v21
    v_add_u32 v22, 32768, v22
    v_add_u32 v23, 32768, v23
    v_mov_b32 v19, 0x3f803f80
    v_and_b32 v30, 31, v0
    v_lshrrev_b32 v31, 5, v0
    s_lshl_b32 s7, s57, 5
    v_add_u32 v33, s7, v30
    v_lshlrev_b32 v33, 3, v33
    v_mov_b32 v36, s4
    v_lshl_add_u32 v36, v36, 4, v0
    v_lshlrev_b32 v36, 7, v36
    s_lshl_b32 s7, s57, 2
    v_add_u32 v36, s7, v36
    v_add_u32 v36, 18350080, v36
    s_waitcnt vmcnt(8)
    s_barrier
    ds_read_b128 v[40:43], v20
    ds_read_b128 v[44:47], v21
    ds_read_b128 v[48:51], v22
    ds_read_b128 v[52:55], v23
    s_cmp_lg_u32 s57, 0
    s_cbranch_scc1 parallel_sum__sliding_block__dense_activation_gelu__prompt_kernel_nobias2
    v_lshlrev_b32 v34, 3, v0
    v_add_u32 v34, 162048, v34
    v_lshlrev_b32 v38, 16, v35
    v_and_b32 v39, 0xffff0000, v35
    v_cmp_gt_u32 vcc, 48, v0
    s_and_saveexec_b64 s[34:35], vcc
    ds_write_b64 v34, v[38:39]
    s_mov_b64 exec, s[34:35]
parallel_sum__sliding_block__dense_activation_gelu__prompt_kernel_nobias2:
    v_mov_b32 v88, 0
    v_mov_b32 v89, 0
    v_mov_b32 v90, 0
    v_mov_b32 v91, 0
    s_mov_b32 m0, s43
    s_add_u32 s48, s48, 1
    buffer_load_dwordx4 v100, s[8:11], s40 offen offset:0 lds
    s_cmp_eq_u32 s48, 10
    s_cselect_b32 s48, 0, s48
    s_cselect_b32 s35, s58, 128
    s_cselect_b32 s34, s59, 245760
    s_waitcnt lgkmcnt(0)
    buffer_load_dwordx4 v101, s[8:11], s40 offen offset:1024 lds
    s_add_u32 s50, s50, 1
    s_cmp_eq_u32 s50, 4
    s_cselect_b32 s32, s51, 32768
    s_cselect_b32 s50, 0, s50
    v_dot2c_f32_bf16 v88, v40, v19
    v_dot2c_f32_bf16 v90, v40, v40
    v_dot2c_f32_bf16 v89, v41, v19
    v_dot2c_f32_bf16 v91, v41, v41
    buffer_load_dwordx4 v102, s[8:11], s40 offen offset:2048 lds
    s_add_u32 s43, s43, s32
    v_dot2c_f32_bf16 v88, v42, v19
    v_dot2c_f32_bf16 v90, v42, v42
    v_dot2c_f32_bf16 v89, v43, v19
    v_dot2c_f32_bf16 v91, v43, v43
    buffer_load_dwordx4 v103, s[8:11], s40 offen offset:3072 lds
    v_dot2c_f32_bf16 v88, v44, v19
    v_dot2c_f32_bf16 v90, v44, v44
    v_dot2c_f32_bf16 v89, v45, v19
    v_dot2c_f32_bf16 v91, v45, v45
    s_mov_b32 m0, s44
    s_add_u32 s40, s40, s35
    v_dot2c_f32_bf16 v88, v46, v19
    v_dot2c_f32_bf16 v90, v46, v46
    v_dot2c_f32_bf16 v89, v47, v19
    v_dot2c_f32_bf16 v91, v47, v47
    buffer_load_dwordx4 v104, s[12:15], s41 offen offset:0 lds
    v_dot2c_f32_bf16 v88, v48, v19
    v_dot2c_f32_bf16 v90, v48, v48
    v_dot2c_f32_bf16 v89, v49, v19
    v_dot2c_f32_bf16 v91, v49, v49
    buffer_load_dwordx4 v105, s[12:15], s41 offen offset:1024 lds
    v_dot2c_f32_bf16 v88, v50, v19
    v_dot2c_f32_bf16 v90, v50, v50
    v_dot2c_f32_bf16 v89, v51, v19
    v_dot2c_f32_bf16 v91, v51, v51
    buffer_load_dwordx4 v106, s[12:15], s41 offen offset:2048 lds
    v_dot2c_f32_bf16 v88, v52, v19
    v_dot2c_f32_bf16 v90, v52, v52
    v_dot2c_f32_bf16 v89, v53, v19
    v_dot2c_f32_bf16 v91, v53, v53
    buffer_load_dwordx4 v107, s[12:15], s41 offen offset:3072 lds
    v_dot2c_f32_bf16 v88, v54, v19
    v_dot2c_f32_bf16 v90, v54, v54
    v_dot2c_f32_bf16 v89, v55, v19
    v_dot2c_f32_bf16 v91, v55, v55
    s_add_u32 s41, s41, s34
    s_add_u32 s44, s44, s32
    s_add_u32 s45, s45, s32
    s_nop 2
    v_add_f32 v88, v88, v89
    v_add_f32 v89, v90, v91
    v_mov_b32 v96, v88
    s_nop 1
    v_permlane32_swap_b32 v96, v88
    s_nop 1
    v_add_f32 v88, v88, v96
    v_mov_b32 v96, v89
    s_nop 1
    v_permlane32_swap_b32 v96, v89
    s_nop 1
    v_add_f32 v89, v89, v96
    s_cmp_ge_u32 s5, 10
    s_cbranch_scc1 parallel_sum__sliding_block__dense_activation_gelu__prompt_kernel_nox
    s_mul_i32 s6, s4, 10
    s_add_u32 s6, s6, s5
    s_lshl_b32 s6, s6, 10
    s_add_u32 s6, s6, 17825792
    s_mov_b64 exec, 0xffffffff
    buffer_store_dwordx2 v[88:89], v33, s[20:23], s6 offen sc1
    s_mov_b64 exec, -1
parallel_sum__sliding_block__dense_activation_gelu__prompt_kernel_nox:
    s_mov_b32 s46, 1
parallel_sum__sliding_block__dense_activation_gelu__prompt_kernel_l1:
    s_waitcnt vmcnt(8)
    s_barrier
    s_cmp_lg_u32 s46, 2
    s_cbranch_scc1 parallel_sum__sliding_block__dense_activation_gelu__prompt_kernel_noflag
    s_mov_b32 s34, 0
parallel_sum__sliding_block__dense_activation_gelu__prompt_kernel_nchk:
    v_cmp_eq_u32 vcc, 0, v18
    s_cbranch_vccz parallel_sum__sliding_block__dense_activation_gelu__prompt_kernel_nok
    s_sleep 1
    buffer_load_dword v18, v17, s[28:31], 0 offen sc1
    s_waitcnt vmcnt(0)
    s_add_u32 s34, s34, 1
    s_cmp_lt_u32 s34, 100000
    s_cbranch_scc1 parallel_sum__sliding_block__dense_activation_gelu__prompt_kernel_nchk
parallel_sum__sliding_block__dense_activation_gelu__prompt_kernel_nok:
    v_readfirstlane_b32 s94, v18
    v_mov_b32 v38, 163456
    ds_write_b32 v38, v18
    s_cmp_ge_u32 s5, 10
    s_cbranch_scc1 parallel_sum__sliding_block__dense_activation_gelu__prompt_kernel_noflag
    s_lshl_b32 s6, s4, 4
    s_add_u32 s6, s6, s5
    s_lshl_b32 s6, s6, 7
    s_lshl_b32 s7, s57, 2
    s_add_u32 s6, s6, s7
    s_add_u32 s6, s6, 18350080
    v_mov_b32 v34, 0
    v_mov_b32 v37, s94
    s_mov_b64 exec, 1
    buffer_store_dword v37, v34, s[20:23], s6 offen sc1
    s_mov_b64 exec, -1
parallel_sum__sliding_block__dense_activation_gelu__prompt_kernel_noflag:
    s_cmp_lg_u32 s46, 6
    s_cbranch_scc1 parallel_sum__sliding_block__dense_activation_gelu__prompt_kernel_np1
    s_mov_b64 exec, 0x3ff
    buffer_load_dword v37, v36, s[20:23], 0 offen sc1
    s_mov_b64 exec, -1
parallel_sum__sliding_block__dense_activation_gelu__prompt_kernel_np1:
    s_mov_b32 m0, s43
    s_add_u32 s48, s48, 1
    buffer_load_dwordx4 v100, s[8:11], s40 offen offset:0 lds
    s_cmp_eq_u32 s48, 10
    s_cselect_b32 s48, 0, s48
    s_cselect_b32 s35, s58, 128
    s_cselect_b32 s34, s59, 245760
    buffer_load_dwordx4 v101, s[8:11], s40 offen offset:1024 lds
    s_add_u32 s50, s50, 1
    s_cmp_eq_u32 s50, 4
    s_cselect_b32 s32, s51, 32768
    s_cselect_b32 s50, 0, s50
    buffer_load_dwordx4 v102, s[8:11], s40 offen offset:2048 lds
    s_add_u32 s43, s43, s32
    buffer_load_dwordx4 v103, s[8:11], s40 offen offset:3072 lds
    s_mov_b32 m0, s44
    s_add_u32 s40, s40, s35
    buffer_load_dwordx4 v104, s[12:15], s41 offen offset:0 lds
    buffer_load_dwordx4 v105, s[12:15], s41 offen offset:1024 lds
    buffer_load_dwordx4 v106, s[12:15], s41 offen offset:2048 lds
    buffer_load_dwordx4 v107, s[12:15], s41 offen offset:3072 lds
    s_add_u32 s41, s41, s34
    s_add_u32 s44, s44, s32
    s_add_u32 s45, s45, s32
    s_add_u32 s46, s46, 1
    s_cmp_lt_u32 s46, 8
    s_cbranch_scc1 parallel_sum__sliding_block__dense_activation_gelu__prompt_kernel_l1
    s_waitcnt vmcnt(8)
    s_barrier
    s_mov_b64 exec, 0x3ff
    v_cmp_ne_u32 vcc, s94, v37
    s_mov_b64 exec, -1
    s_cbranch_vccz parallel_sum__sliding_block__dense_activation_gelu__prompt_kernel_xok
    s_mov_b64 exec, 0x3ff
    s_mov_b32 s34, 0
parallel_sum__sliding_block__dense_activation_gelu__prompt_kernel_px:
    buffer_load_dword v37, v36, s[20:23], 0 offen sc1
    s_waitcnt vmcnt(0)
    v_cmp_ne_u32 vcc, s94, v37
    s_cbranch_vccz parallel_sum__sliding_block__dense_activation_gelu__prompt_kernel_px_ok
    s_sleep 2
    s_add_u32 s34, s34, 1
    s_cmp_lt_u32 s34, 100000
    s_cbranch_scc1 parallel_sum__sliding_block__dense_activation_gelu__prompt_kernel_px
parallel_sum__sliding_block__dense_activation_gelu__prompt_kernel_px_ok:
    s_mov_b64 exec, -1
parallel_sum__sliding_block__dense_activation_gelu__prompt_kernel_xok:
    v_mul_u32_u24 v34, 5120, v31
    v_add_u32 v34, v34, v33
    s_mul_i32 s6, s4, 10240
    s_add_u32 s6, s6, 17825792
    buffer_load_dwordx2 v[40:41], v34, s[20:23], s6 offen offset:0 sc1
    buffer_load_dwordx2 v[42:43], v34, s[20:23], s6 offen offset:1024 sc1
    buffer_load_dwordx2 v[44:45], v34, s[20:23], s6 offen offset:2048 sc1
    buffer_load_dwordx2 v[46:47], v34, s[20:23], s6 offen offset:3072 sc1
    s_add_u32 s6, s6, 4096
    buffer_load_dwordx2 v[48:49], v34, s[20:23], s6 offen offset:0 sc1
    s_mov_b32 m0, s43
    s_add_u32 s48, s48, 1
    buffer_load_dwordx4 v100, s[8:11], s40 offen offset:0 lds
    s_cmp_eq_u32 s48, 10
    s_cselect_b32 s48, 0, s48
    s_cselect_b32 s35, s58, 128
    s_cselect_b32 s34, s49, 196608
    buffer_load_dwordx4 v101, s[8:11], s40 offen offset:1024 lds
    s_add_u32 s50, s50, 1
    s_cmp_eq_u32 s50, 4
    s_cselect_b32 s32, s51, 32768
    s_cselect_b32 s50, 0, s50
    buffer_load_dwordx4 v102, s[8:11], s40 offen offset:2048 lds
    s_add_u32 s43, s43, s32
    buffer_load_dwordx4 v103, s[8:11], s40 offen offset:3072 lds
    s_mov_b32 m0, s45
    s_add_u32 s40, s40, s35
    buffer_load_dwordx4 v108, s[16:19], s42 offen offset:0 lds
    buffer_load_dwordx4 v109, s[16:19], s42 offen offset:1024 lds
    buffer_load_dwordx4 v110, s[16:19], s42 offen offset:2048 lds
    s_add_u32 s42, s42, s34
    s_add_u32 s44, s44, s32
    s_add_u32 s45, s45, s32
    s_waitcnt vmcnt(12)
    s_barrier
    s_mov_b32 m0, s43
    s_add_u32 s48, s48, 1
    buffer_load_dwordx4 v100, s[8:11], s40 offen offset:0 lds
    s_cmp_eq_u32 s48, 10
    s_cselect_b32 s48, 0, s48
    s_cselect_b32 s35, s58, 128
    s_cselect_b32 s34, s49, 196608
    buffer_load_dwordx4 v101, s[8:11], s40 offen offset:1024 lds
    s_add_u32 s50, s50, 1
    s_cmp_eq_u32 s50, 4
    s_cselect_b32 s32, s51, 32768
    s_cselect_b32 s50, 0, s50
    buffer_load_dwordx4 v102, s[8:11], s40 offen offset:2048 lds
    s_add_u32 s43, s43, s32
    buffer_load_dwordx4 v103, s[8:11], s40 offen offset:3072 lds
    s_mov_b32 m0, s45
    s_add_u32 s40, s40, s35
    buffer_load_dwordx4 v108, s[16:19], s42 offen offset:0 lds
    buffer_load_dwordx4 v109, s[16:19], s42 offen offset:1024 lds
    buffer_load_dwordx4 v110, s[16:19], s42 offen offset:2048 lds
    s_add_u32 s42, s42, s34
    s_add_u32 s44, s44, s32
    s_add_u32 s45, s45, s32
    s_waitcnt vmcnt(14)
    v_add_f32 v40, v40, v42
    v_add_f32 v41, v41, v43
    v_add_f32 v40, v40, v44
    v_add_f32 v41, v41, v45
    v_add_f32 v40, v40, v46
    v_add_f32 v41, v41, v47
    v_add_f32 v40, v40, v48
    v_add_f32 v41, v41, v49
    v_mov_b32 v96, v40
    s_nop 1
    v_permlane32_swap_b32 v96, v40
    s_nop 1
    v_add_f32 v40, v40, v96
    v_mov_b32 v96, v41
    s_nop 1
    v_permlane32_swap_b32 v96, v41
    s_nop 1
    v_add_f32 v41, v41, v96
    v_mul_f32 v40, 0x3acccccd, v40
    v_mul_f32 v41, 0x3acccccd, v41
    v_fma_f32 v41, -v40, v40, v41
    v_add_f32 v41, 0x3727c5ac, v41
    v_rsq_f32 v42, v41
    s_nop 0
    v_mul_f32 v43, v40, v42
    v_sub_f32 v43, 0, v43
    v_add_u32 v33, 162432, v33
    ds_write_b64 v33, v[42:43]
    s_waitcnt lgkmcnt(0)
    s_barrier
    s_mov_b32 m0, s43
    s_add_u32 s48, s48, 1
    buffer_load_dwordx4 v100, s[8:11], s40 offen offset:0 lds
    s_cmp_eq_u32 s48, 10
    s_cselect_b32 s48, 0, s48
    s_cselect_b32 s35, s58, 128
    s_cselect_b32 s34, s49, 196608
    buffer_load_dwordx4 v101, s[8:11], s40 offen offset:1024 lds
    s_add_u32 s50, s50, 1
    s_cmp_eq_u32 s50, 4
    s_cselect_b32 s32, s51, 32768
    s_cselect_b32 s50, 0, s50
    buffer_load_dwordx4 v102, s[8:11], s40 offen offset:2048 lds
    s_add_u32 s43, s43, s32
    buffer_load_dwordx4 v103, s[8:11], s40 offen offset:3072 lds
    s_mov_b32 m0, s45
    s_add_u32 s40, s40, s35
    buffer_load_dwordx4 v108, s[16:19], s42 offen offset:0 lds
    buffer_load_dwordx4 v109, s[16:19], s42 offen offset:1024 lds
    buffer_load_dwordx4 v110, s[16:19], s42 offen offset:2048 lds
    s_add_u32 s42, s42, s34
    s_add_u32 s44, s44, s32
    s_add_u32 s45, s45, s32
    s_and_b32 s6, s2, 7
    s_lshr_b32 s7, s2, 3
    s_and_b32 s54, s7, 15
    s_lshr_b32 s7, s7, 4
    s_lshl_b32 s6, s6, 1
    s_add_u32 s55, s6, s7
    s_mul_i32 s6, s55, 40
    s_add_u32 s7, s6, 39
    s_lshr_b32 s6, s6, 7
    s_lshr_b32 s7, s7, 7
    v_mul_u32_u24 v30, 43, v0
    v_lshrrev_b32 v30, 8, v30
    v_mul_u32_u24 v31, 6, v30
    v_sub_u32 v31, v0, v31
    v_lshrrev_b32 v31, 1, v31
    v_sub_u32 v31, s54, v31
    v_max_i32 v31, 0, v31
    v_mul_u32_u24 v30, 5, v30
    v_lshl_add_u32 v30, v31, 4, v30
    v_and_b32 v31, 1, v0
    v_cmp_eq_u32 vcc, 0, v31
    v_mov_b32 v31, s6
    v_mov_b32 v32, s7
    v_cndmask_b32 v31, v32, v31, vcc
    v_add_u32 v30, v30, v31
    v_lshlrev_b32 v30, 7, v30
    v_add_u32 v36, 18415616, v30
    v_lshlrev_b32 v1, 4, v0
    s_and_b32 s6, s57, 1
    s_lshr_b32 s7, s57, 1
    s_mul_i32 s32, s7, 6208
    s_lshl_b32 s33, s6, 9
    s_add_u32 s32, s32, s33
    s_add_u32 s32, s32, 98304
    v_lshlrev_b32 v2, 3, v0
    v_add_u32 v2, s32, v2
    s_mul_i32 s32, s55, 5
    s_add_u32 s32, s32, s7
    s_add_u32 s32, s32, 80
    s_lshl_b32 s32, s32, 11
    s_lshl_b32 s33, s6, 10
    s_add_u32 s32, s32, s33
    s_add_u32 s52, s32, 9437184
    s_mul_i32 s53, s7, 75
    s_add_u32 s53, s53, 4
    s_lshl_b32 s53, s53, 11
    s_mov_b32 s46, 10
parallel_sum__sliding_block__dense_activation_gelu__prompt_kernel_l2:
    s_waitcnt vmcnt(14)
    s_barrier
    s_mov_b32 m0, s43
    s_add_u32 s48, s48, 1
    buffer_load_dwordx4 v100, s[8:11], s40 offen offset:0 lds
    s_cmp_eq_u32 s48, 10
    s_cselect_b32 s48, 0, s48
    s_cselect_b32 s35, s58, 128
    s_cselect_b32 s34, s49, 196608
    buffer_load_dwordx4 v101, s[8:11], s40 offen offset:1024 lds
    s_add_u32 s50, s50, 1
    s_cmp_eq_u32 s50, 4
    s_cselect_b32 s32, s51, 32768
    s_cselect_b32 s50, 0, s50
    buffer_load_dwordx4 v102, s[8:11], s40 offen offset:2048 lds
    s_add_u32 s43, s43, s32
    buffer_load_dwordx4 v103, s[8:11], s40 offen offset:3072 lds
    s_mov_b32 m0, s45
    s_add_u32 s40, s40, s35
    buffer_load_dwordx4 v108, s[16:19], s42 offen offset:0 lds
    buffer_load_dwordx4 v109, s[16:19], s42 offen offset:1024 lds
    buffer_load_dwordx4 v110, s[16:19], s42 offen offset:2048 lds
    s_add_u32 s42, s42, s34
    s_add_u32 s44, s44, s32
    s_add_u32 s45, s45, s32
    s_add_u32 s46, s46, 1
    s_cmp_lt_u32 s46, 17
    s_cbranch_scc1 parallel_sum__sliding_block__dense_activation_gelu__prompt_kernel_l2
    s_waitcnt vmcnt(14)
    s_barrier
    s_mov_b64 exec, 0x3ffff
    buffer_load_dword v37, v36, s[20:23], 0 offen sc1
    s_mov_b64 exec, -1
    s_waitcnt vmcnt(8)
    s_barrier
    s_waitcnt vmcnt(0)
    s_barrier
    s_mov_b64 exec, 0x3ffff
    v_cmp_ne_u32 vcc, s94, v37
    s_mov_b64 exec, -1
    s_cbranch_vccz parallel_sum__sliding_block__dense_activation_gelu__prompt_kernel_depok
    s_mov_b64 exec, 0x3ffff
    s_mov_b32 s34, 0
parallel_sum__sliding_block__dense_activation_gelu__prompt_kernel_pq:
    buffer_load_dword v37, v36, s[20:23], 0 offen sc1
    s_waitcnt vmcnt(0)
    v_cmp_ne_u32 vcc, s94, v37
    s_cbranch_vccz parallel_sum__sliding_block__dense_activation_gelu__prompt_kernel_pq_ok
    s_sleep 2
    s_add_u32 s34, s34, 1
    s_cmp_lt_u32 s34, 100000
    s_cbranch_scc1 parallel_sum__sliding_block__dense_activation_gelu__prompt_kernel_pq
parallel_sum__sliding_block__dense_activation_gelu__prompt_kernel_pq_ok:
    s_mov_b64 exec, -1
parallel_sum__sliding_block__dense_activation_gelu__prompt_kernel_depok:
    v_mov_b32 v30, 163488
    v_mov_b32 v31, 1
    ds_write_b32 v30, v31
    s_sub_i32 s6, s54, 0
    s_max_i32 s6, s6, 0
    s_mul_i32 s6, s6, 491520
    s_add_u32 s6, s6, s52
    s_add_u32 s7, s6, 0
    buffer_load_dwordx4 v[40:43], v1, s[20:23], s7 offen sc1
    s_add_u32 s7, s6, 4096
    buffer_load_dwordx4 v[44:47], v1, s[20:23], s7 offen sc1
    s_add_u32 s7, s6, s53
    buffer_load_dwordx4 v[48:51], v1, s[20:23], s7 offen sc1
    s_add_u32 s7, s6, 165888
    buffer_load_dwordx4 v[52:55], v1, s[20:23], s7 offen sc1
    s_add_u32 s7, s6, 169984
    buffer_load_dwordx4 v[56:59], v1, s[20:23], s7 offen sc1
    s_sub_i32 s6, s54, 1
    s_max_i32 s6, s6, 0
    s_mul_i32 s6, s6, 491520
    s_add_u32 s6, s6, s52
    s_add_u32 s7, s6, 0
    buffer_load_dwordx4 v[60:63], v1, s[20:23], s7 offen sc1
    s_add_u32 s7, s6, 4096
    buffer_load_dwordx4 v[64:67], v1, s[20:23], s7 offen sc1
    s_add_u32 s7, s6, s53
    buffer_load_dwordx4 v[68:71], v1, s[20:23], s7 offen sc1
    s_add_u32 s7, s6, 165888
    buffer_load_dwordx4 v[72:75], v1, s[20:23], s7 offen sc1
    s_add_u32 s7, s6, 169984
    buffer_load_dwordx4 v[76:79], v1, s[20:23], s7 offen sc1
    s_sub_i32 s6, s54, 2
    s_max_i32 s6, s6, 0
    s_mul_i32 s6, s6, 491520
    s_add_u32 s6, s6, s52
    s_add_u32 s7, s6, 0
    buffer_load_dwordx4 v[80:83], v1, s[20:23], s7 offen sc1
    s_add_u32 s7, s6, 4096
    buffer_load_dwordx4 v[84:87], v1, s[20:23], s7 offen sc1
    s_add_u32 s7, s6, s53
    buffer_load_dwordx4 v[88:91], v1, s[20:23], s7 offen sc1
    s_add_u32 s7, s6, 165888
    buffer_load_dwordx4 v[92:95], v1, s[20:23], s7 offen sc1
    s_add_u32 s7, s6, 169984
    buffer_load_dwordx4 v[96:99], v1, s[20:23], s7 offen sc1
    s_sub_u32 s3, s3, 4
    s_and_b32 s6, s2, 7
    s_lshr_b32 s7, s2, 3
    s_lshr_b32 s38, s6, 1
    s_and_b32 s39, s6, 1
    s_mul_i32 s5, s7, 52
    s_lshr_b32 s4, s5, 8
    s_mul_i32 s5, s4, 5
    s_sub_u32 s5, s7, s5
    s_mul_i32 s39, s39, 5
    s_add_u32 s5, s5, s39
    s_and_b32 s39, s38, 1
    s_sub_u32 s39, 6, s39
    s_cmp_ge_u32 s4, s39
    s_cselect_b32 s46, 1, 0
    s_mul_i32 s39, s38, 11
    s_add_u32 s39, s39, 1
    s_lshr_b32 s39, s39, 1
    s_add_u32 s4, s4, s39
    v_and_b32 v188, 31, v0
    v_lshrrev_b32 v189, 5, v0
    v_lshlrev_b32 v184, 4, v0
    v_lshrrev_b32 v190, 3, v0
    v_bfe_u32 v191, v0, 2, 1
    v_bfe_u32 v192, v0, 4, 1
    v_xor_b32 v191, v191, v192
    v_and_b32 v192, 3, v0
    v_lshlrev_b32 v192, 4, v192
    v_lshl_add_u32 v192, v191, 6, v192
    v_mul_u32_u24 v185, 1280, v190
    v_add_u32 v185, v185, v192
    v_add_u32 v193, 9216, v185
    v_bfe_u32 v190, v0, 2, 2
    v_and_b32 v191, 3, v0
    v_bfe_u32 v192, v0, 4, 1
    v_lshl_add_u32 v191, v192, 2, v191
    v_lshl_add_u32 v192, v189, 3, v190
    v_lshlrev_b32 v192, 7, v192
    v_lshl_add_u32 v192, v191, 3, v192
    v_lshrrev_b32 v190, 1, v190
    s_mul_i32 s42, s3, 24576
    v_add_u32 v192, s42, v192
    v_lshl_add_u32 v186, v190, 6, v192
    v_xor_b32 v187, 64, v186
    s_mov_b32 s12, s68
    s_mov_b32 s13, s69
    s_mov_b32 s14, s70
    s_mov_b32 s15, 0x20000
    s_mul_i32 s6, s3, 24
    s_mul_i32 s41, s6, 20480
    s_lshl_b32 s7, s5, 7
    s_add_u32 s41, s41, s7
    s_mul_i32 s7, s4, 408
    s_add_u32 s6, s6, s7
    s_add_u32 s6, s6, 40
    s_lshl_b32 s40, s6, 10
    s_add_u32 s40, s40, 0
    s_add_u32 s44, s40, 139264
    s_add_u32 s45, s40, 278528
    s_mul_i32 s6, s4, 96
    s_add_u32 s7, s6, 95
    s_lshr_b32 s6, s6, 7
    s_lshr_b32 s7, s7, 7
    s_min_u32 s7, s7, 15
    v_mov_b32 v190, s6
    v_mov_b32 v191, s7
    v_and_b32 v192, 4, v0
    v_cmp_eq_u32 vcc, 0, v192
    v_cndmask_b32 v190, v191, v190, vcc
    v_and_b32 v191, 3, v0
    s_lshl_b32 s6, s3, 2
    v_add_u32 v191, s6, v191
    v_lshl_add_u32 v190, v190, 4, v191
    v_lshlrev_b32 v190, 7, v190
    v_add_u32 v196, 18415680, v190
    v_add_u32 v198, 65472, v196
    v_mul_u32_u24 v200, 1280, v0
    s_lshl_b32 s7, s5, 7
    v_add_u32 v200, s7, v200
    s_waitcnt vmcnt(14)
    ds_write_b64 v2, v[40:41] offset:2048
    ds_write_b64 v2, v[42:43] offset:5152
    s_waitcnt vmcnt(13)
    ds_write_b64 v2, v[44:45] offset:14464
    ds_write_b64 v2, v[46:47] offset:17568
    s_waitcnt vmcnt(12)
    ds_write_b64 v2, v[48:49] offset:26880
    ds_write_b64 v2, v[50:51] offset:29984
    s_waitcnt vmcnt(11)
    ds_write_b64 v2, v[52:53] offset:39296
    ds_write_b64 v2, v[54:55] offset:42400
    s_waitcnt vmcnt(10)
    ds_write_b64 v2, v[56:57] offset:51712
    ds_write_b64 v2, v[58:59] offset:54816
    s_waitcnt vmcnt(9)
    ds_write_b64 v2, v[60:61] offset:1024
    ds_write_b64 v2, v[62:63] offset:4128
    s_waitcnt vmcnt(8)
    ds_write_b64 v2, v[64:65] offset:13440
    ds_write_b64 v2, v[66:67] offset:16544
    s_waitcnt vmcnt(7)
    ds_write_b64 v2, v[68:69] offset:25856
    ds_write_b64 v2, v[70:71] offset:28960
    s_waitcnt vmcnt(6)
    ds_write_b64 v2, v[72:73] offset:38272
    ds_write_b64 v2, v[74:75] offset:41376
    s_waitcnt vmcnt(5)
    ds_write_b64 v2, v[76:77] offset:50688
    ds_write_b64 v2, v[78:79] offset:53792
    s_waitcnt vmcnt(4)
    ds_write_b64 v2, v[80:81] offset:0
    ds_write_b64 v2, v[82:83] offset:3104
    s_waitcnt vmcnt(3)
    ds_write_b64 v2, v[84:85] offset:12416
    ds_write_b64 v2, v[86:87] offset:15520
    s_waitcnt vmcnt(2)
    ds_write_b64 v2, v[88:89] offset:24832
    ds_write_b64 v2, v[90:91] offset:27936
    s_waitcnt vmcnt(1)
    ds_write_b64 v2, v[92:93] offset:37248
    ds_write_b64 v2, v[94:95] offset:40352
    s_waitcnt vmcnt(0)
    ds_write_b64 v2, v[96:97] offset:49664
    ds_write_b64 v2, v[98:99] offset:52768
    s_waitcnt lgkmcnt(0)
    v_mov_b32 v30, 163480
    v_mov_b32 v31, 1
    s_mov_b64 exec, 1
    ds_add_u32 v30, v31
    s_mov_b64 exec, -1
    v_mov_b32 v30, 163492
    s_mov_b32 s33, 0
parallel_sum__sliding_block__dense_activation_gelu__prompt_kernel_we2l:
    ds_read_b32 v31, v30
    s_waitcnt lgkmcnt(0)
    v_readfirstlane_b32 s32, v31
    s_cmp_ge_u32 s32, 4
    s_cbranch_scc1 parallel_sum__sliding_block__dense_activation_gelu__prompt_kernel_we2l_ok
    s_sleep 1
    s_add_u32 s33, s33, 1
    s_cmp_lt_u32 s33, 1600000
    s_cbranch_scc1 parallel_sum__sliding_block__dense_activation_gelu__prompt_kernel_we2l
parallel_sum__sliding_block__dense_activation_gelu__prompt_kernel_we2l_ok:
    s_add_u32 m0, s42, 0
    s_add_u32 s33, s41, 20480
    buffer_load_dwordx4 v185, s[12:15], s41 offen lds
    buffer_load_dwordx4 v193, s[12:15], s41 offen offset:1024 lds
    s_mov_b32 s41, s33
    s_add_u32 m0, s42, 2048
    s_add_u32 s33, s41, 20480
    buffer_load_dwordx4 v185, s[12:15], s41 offen lds
    buffer_load_dwordx4 v193, s[12:15], s41 offen offset:1024 lds
    s_mov_b32 s41, s33
    s_add_u32 m0, s42, 4096
    s_add_u32 s33, s41, 20480
    buffer_load_dwordx4 v185, s[12:15], s41 offen lds
    buffer_load_dwordx4 v193, s[12:15], s41 offen offset:1024 lds
    s_mov_b32 s41, s33
    s_add_u32 m0, s42, 6144
    s_add_u32 s33, s41, 20480
    buffer_load_dwordx4 v185, s[12:15], s41 offen lds
    buffer_load_dwordx4 v193, s[12:15], s41 offen offset:1024 lds
    s_mov_b32 s41, s33
    s_add_u32 m0, s42, 8192
    s_add_u32 s33, s41, 20480
    buffer_load_dwordx4 v185, s[12:15], s41 offen lds
    buffer_load_dwordx4 v193, s[12:15], s41 offen offset:1024 lds
    s_mov_b32 s41, s33
    s_add_u32 m0, s42, 10240
    s_add_u32 s33, s41, 20480
    buffer_load_dwordx4 v185, s[12:15], s41 offen lds
    buffer_load_dwordx4 v193, s[12:15], s41 offen offset:1024 lds
    s_mov_b32 s41, s33
    s_add_u32 m0, s42, 12288
    s_add_u32 s33, s41, 20480
    buffer_load_dwordx4 v185, s[12:15], s41 offen lds
    buffer_load_dwordx4 v193, s[12:15], s41 offen offset:1024 lds
    s_mov_b32 s41, s33
    s_add_u32 m0, s42, 14336
    s_add_u32 s33, s41, 20480
    buffer_load_dwordx4 v185, s[12:15], s41 offen lds
    buffer_load_dwordx4 v193, s[12:15], s41 offen offset:1024 lds
    s_mov_b32 s41, s33
    s_add_u32 m0, s42, 16384
    s_add_u32 s33, s41, 20480
    buffer_load_dwordx4 v185, s[12:15], s41 offen lds
    buffer_load_dwordx4 v193, s[12:15], s41 offen offset:1024 lds
    s_mov_b32 s41, s33
    s_add_u32 m0, s42, 18432
    s_add_u32 s33, s41, 20480
    buffer_load_dwordx4 v185, s[12:15], s41 offen lds
    buffer_load_dwordx4 v193, s[12:15], s41 offen offset:1024 lds
    s_mov_b32 s41, s33
    s_add_u32 m0, s42, 20480
    s_add_u32 s33, s41, 20480
    buffer_load_dwordx4 v185, s[12:15], s41 offen lds
    buffer_load_dwordx4 v193, s[12:15], s41 offen offset:1024 lds
    s_mov_b32 s41, s33
    s_add_u32 m0, s42, 22528
    s_add_u32 s33, s41, 20480
    buffer_load_dwordx4 v185, s[12:15], s41 offen lds
    buffer_load_dwordx4 v193, s[12:15], s41 offen offset:1024 lds
    s_mov_b32 s41, s33
    s_waitcnt vmcnt(10)
    ds_read_b64_tr_b16 v[200:201], v186 offset:0
    ds_read_b64_tr_b16 v[202:203], v186 offset:512
    ds_read_b64_tr_b16 v[204:205], v187 offset:0
    ds_read_b64_tr_b16 v[206:207], v187 offset:512
    ds_read_b64_tr_b16 v[208:209], v186 offset:2048
    ds_read_b64_tr_b16 v[210:211], v186 offset:2560
    ds_read_b64_tr_b16 v[212:213], v187 offset:2048
    ds_read_b64_tr_b16 v[214:215], v187 offset:2560
    ds_read_b64_tr_b16 v[216:217], v186 offset:4096
    ds_read_b64_tr_b16 v[218:219], v186 offset:4608
    ds_read_b64_tr_b16 v[220:221], v187 offset:4096
    ds_read_b64_tr_b16 v[222:223], v187 offset:4608
    ds_read_b64_tr_b16 v[224:225], v186 offset:6144
    ds_read_b64_tr_b16 v[226:227], v186 offset:6656
    ds_read_b64_tr_b16 v[228:229], v187 offset:6144
    ds_read_b64_tr_b16 v[230:231], v187 offset:6656
    ds_read_b64_tr_b16 v[232:233], v186 offset:8192
    ds_read_b64_tr_b16 v[234:235], v186 offset:8704
    ds_read_b64_tr_b16 v[236:237], v187 offset:8192
    ds_read_b64_tr_b16 v[238:239], v187 offset:8704
    ds_read_b64_tr_b16 v[240:241], v186 offset:10240
    ds_read_b64_tr_b16 v[242:243], v186 offset:10752
    ds_read_b64_tr_b16 v[244:245], v187 offset:10240
    ds_read_b64_tr_b16 v[246:247], v187 offset:10752
    ds_read_b64_tr_b16 v[248:249], v186 offset:12288
    ds_read_b64_tr_b16 v[250:251], v186 offset:12800
    ds_read_b64_tr_b16 v[252:253], v187 offset:12288
    ds_read_b64_tr_b16 v[254:255], v187 offset:12800
    s_waitcnt lgkmcnt(0)
    s_add_u32 m0, s42, 0
    s_add_u32 s33, s41, 20480
    buffer_load_dwordx4 v185, s[12:15], s41 offen lds
    buffer_load_dwordx4 v193, s[12:15], s41 offen offset:1024 lds
    s_mov_b32 s41, s33
    s_add_u32 m0, s42, 2048
    s_add_u32 s33, s41, 20480
    buffer_load_dwordx4 v185, s[12:15], s41 offen lds
    buffer_load_dwordx4 v193, s[12:15], s41 offen offset:1024 lds
    s_mov_b32 s41, s33
    s_add_u32 m0, s42, 4096
    s_add_u32 s33, s41, 20480
    buffer_load_dwordx4 v185, s[12:15], s41 offen lds
    buffer_load_dwordx4 v193, s[12:15], s41 offen offset:1024 lds
    s_mov_b32 s41, s33
    s_add_u32 m0, s42, 6144
    s_add_u32 s33, s41, 20480
    buffer_load_dwordx4 v185, s[12:15], s41 offen lds
    buffer_load_dwordx4 v193, s[12:15], s41 offen offset:1024 lds
    s_mov_b32 s41, s33
    s_add_u32 m0, s42, 8192
    s_add_u32 s33, s41, 20480
    buffer_load_dwordx4 v185, s[12:15], s41 offen lds
    buffer_load_dwordx4 v193, s[12:15], s41 offen offset:1024 lds
    s_mov_b32 s41, s33
    s_add_u32 m0, s42, 10240
    s_add_u32 s33, s41, 20480
    buffer_load_dwordx4 v185, s[12:15], s41 offen lds
    buffer_load_dwordx4 v193, s[12:15], s41 offen offset:1024 lds
    s_mov_b32 s41, s33
    s_add_u32 m0, s42, 12288
    s_add_u32 s33, s41, 20480
    buffer_load_dwordx4 v185, s[12:15], s41 offen lds
    buffer_load_dwordx4 v193, s[12:15], s41 offen offset:1024 lds
    s_mov_b32 s41, s33
    s_cmp_lg_u32 s46, 0
    s_cbranch_scc1 parallel_sum__sliding_block__dense_activation_gelu__prompt_kernel_end
    s_mov_b32 s24, s98
    s_and_b32 s25, s99, 0xffff
    s_mov_b32 s26, 1280
    s_mov_b32 s27, 0x20000
    s_mov_b32 s28, s100
    s_and_b32 s29, s101, 0xffff
    s_mov_b32 s30, 2621440
    s_mov_b32 s31, 0x20000
    v_mov_b32 v0, 0
    v_mov_b32 v1, 0
    v_mov_b32 v2, 0
    v_mov_b32 v3, 0
    v_mov_b32 v4, 0
    v_mov_b32 v5, 0
    v_mov_b32 v6, 0
    v_mov_b32 v7, 0
    v_mov_b32 v8, 0
    v_mov_b32 v9, 0
    v_mov_b32 v10, 0
    v_mov_b32 v11, 0
    v_mov_b32 v12, 0
    v_mov_b32 v13, 0
    v_mov_b32 v14, 0
    v_mov_b32 v15, 0
    v_mov_b32 v16, 0
    v_mov_b32 v17, 0
    v_mov_b32 v18, 0
    v_mov_b32 v19, 0
    v_mov_b32 v20, 0
    v_mov_b32 v21, 0
    v_mov_b32 v22, 0
    v_mov_b32 v23, 0
    v_mov_b32 v24, 0
    v_mov_b32 v25, 0
    v_mov_b32 v26, 0
    v_mov_b32 v27, 0
    v_mov_b32 v28, 0
    v_mov_b32 v29, 0
    v_mov_b32 v30, 0
    v_mov_b32 v31, 0
    v_mov_b32 v32, 0
    v_mov_b32 v33, 0
    v_mov_b32 v34, 0
    v_mov_b32 v35, 0
    v_mov_b32 v36, 0
    v_mov_b32 v37, 0
    v_mov_b32 v38, 0
    v_mov_b32 v39, 0
    v_mov_b32 v40, 0
    v_mov_b32 v41, 0
    v_mov_b32 v42, 0
    v_mov_b32 v43, 0
    v_mov_b32 v44, 0
    v_mov_b32 v45, 0
    v_mov_b32 v46, 0
    v_mov_b32 v47, 0
    v_mov_b32 v48, 0
    v_mov_b32 v49, 0
    v_mov_b32 v50, 0
    v_mov_b32 v51, 0
    v_mov_b32 v52, 0
    v_mov_b32 v53, 0
    v_mov_b32 v54, 0
    v_mov_b32 v55, 0
    v_mov_b32 v56, 0
    v_mov_b32 v57, 0
    v_mov_b32 v58, 0
    v_mov_b32 v59, 0
    v_mov_b32 v60, 0
    v_mov_b32 v61, 0
    v_mov_b32 v62, 0
    v_mov_b32 v63, 0
    v_mov_b32 v64, 0
    v_mov_b32 v65, 0
    v_mov_b32 v66, 0
    v_mov_b32 v67, 0
    v_mov_b32 v68, 0
    v_mov_b32 v69, 0
    v_mov_b32 v70, 0
    v_mov_b32 v71, 0
    v_mov_b32 v72, 0
    v_mov_b32 v73, 0
    v_mov_b32 v74, 0
    v_mov_b32 v75, 0
    v_mov_b32 v76, 0
    v_mov_b32 v77, 0
    v_mov_b32 v78, 0
    v_mov_b32 v79, 0
    v_mov_b32 v80, 0
    v_mov_b32 v81, 0
    v_mov_b32 v82, 0
    v_mov_b32 v83, 0
    v_mov_b32 v84, 0
    v_mov_b32 v85, 0
    v_mov_b32 v86, 0
    v_mov_b32 v87, 0
    v_mov_b32 v88, 0
    v_mov_b32 v89, 0
    v_mov_b32 v90, 0
    v_mov_b32 v91, 0
    v_mov_b32 v92, 0
    v_mov_b32 v93, 0
    v_mov_b32 v94, 0
    v_mov_b32 v95, 0
    s_mov_b64 exec, 0xff
    s_mov_b32 s34, 0
    buffer_load_dword v197, v196, s[20:23], 0 offen sc1
    s_sleep 2
parallel_sum__sliding_block__dense_activation_gelu__prompt_kernel_g_ph:
    buffer_load_dword v199, v196, s[20:23], 0 offen sc1
    s_waitcnt vmcnt(1)
    v_cmp_ne_u32 vcc, s94, v197
    s_cbranch_vccz parallel_sum__sliding_block__dense_activation_gelu__prompt_kernel_g_ph_ok
    s_sleep 1
    buffer_load_dword v197, v196, s[20:23], 0 offen sc1
    s_waitcnt vmcnt(1)
    v_cmp_ne_u32 vcc, s94, v199
    s_cbranch_vccz parallel_sum__sliding_block__dense_activation_gelu__prompt_kernel_g_ph_ok
    s_sleep 1
    s_add_u32 s34, s34, 1
    s_cmp_lt_u32 s34, 100000
    s_cbranch_scc1 parallel_sum__sliding_block__dense_activation_gelu__prompt_kernel_g_ph
parallel_sum__sliding_block__dense_activation_gelu__prompt_kernel_g_ph_ok:
    s_mov_b64 exec, -1
    buffer_load_dwordx4 v[96:99], v184, s[20:23], s40 offen sc1
    buffer_load_dwordx4 v[100:103], v184, s[20:23], s44 offen sc1
    buffer_load_dwordx4 v[104:107], v184, s[20:23], s45 offen sc1
    s_add_u32 s40, s40, 1024
    s_add_u32 s44, s44, 1024
    s_add_u32 s45, s45, 1024
    buffer_load_dwordx4 v[108:111], v184, s[20:23], s40 offen sc1
    buffer_load_dwordx4 v[112:115], v184, s[20:23], s44 offen sc1
    buffer_load_dwordx4 v[116:119], v184, s[20:23], s45 offen sc1
    s_add_u32 s40, s40, 1024
    s_add_u32 s44, s44, 1024
    s_add_u32 s45, s45, 1024
    buffer_load_dwordx4 v[120:123], v184, s[20:23], s40 offen sc1
    buffer_load_dwordx4 v[124:127], v184, s[20:23], s44 offen sc1
    buffer_load_dwordx4 v[128:131], v184, s[20:23], s45 offen sc1
    s_add_u32 s40, s40, 1024
    s_add_u32 s44, s44, 1024
    s_add_u32 s45, s45, 1024
    buffer_load_dwordx4 v[132:135], v184, s[20:23], s40 offen sc1
    buffer_load_dwordx4 v[136:139], v184, s[20:23], s44 offen sc1
    buffer_load_dwordx4 v[140:143], v184, s[20:23], s45 offen sc1
    s_add_u32 s40, s40, 1024
    s_add_u32 s44, s44, 1024
    s_add_u32 s45, s45, 1024
    buffer_load_dwordx4 v[144:147], v184, s[20:23], s40 offen sc1
    buffer_load_dwordx4 v[148:151], v184, s[20:23], s44 offen sc1
    buffer_load_dwordx4 v[152:155], v184, s[20:23], s45 offen sc1
    s_add_u32 s40, s40, 1024
    s_add_u32 s44, s44, 1024
    s_add_u32 s45, s45, 1024
    buffer_load_dwordx4 v[156:159], v184, s[20:23], s40 offen sc1
    buffer_load_dwordx4 v[160:163], v184, s[20:23], s44 offen sc1
    buffer_load_dwordx4 v[164:167], v184, s[20:23], s45 offen sc1
    s_add_u32 s40, s40, 1024
    s_add_u32 s44, s44, 1024
    s_add_u32 s45, s45, 1024
    s_waitcnt vmcnt(15)
    v_mfma_f32_32x32x16_bf16 v[0:15], v[200:203], v[96:99], v[0:15]
    v_mfma_f32_32x32x16_bf16 v[16:31], v[204:207], v[96:99], v[16:31]
    v_mfma_f32_32x32x16_bf16 v[32:47], v[200:203], v[100:103], v[32:47]
    v_mfma_f32_32x32x16_bf16 v[48:63], v[204:207], v[100:103], v[48:63]
    v_mfma_f32_32x32x16_bf16 v[64:79], v[200:203], v[104:107], v[64:79]
    v_mfma_f32_32x32x16_bf16 v[80:95], v[204:207], v[104:107], v[80:95]
    buffer_load_dwordx4 v[96:99], v184, s[20:23], s40 offen sc1
    buffer_load_dwordx4 v[100:103], v184, s[20:23], s44 offen sc1
    buffer_load_dwordx4 v[104:107], v184, s[20:23], s45 offen sc1
    s_add_u32 s40, s40, 1024
    s_add_u32 s44, s44, 1024
    s_add_u32 s45, s45, 1024
    s_waitcnt vmcnt(15)
    v_mfma_f32_32x32x16_bf16 v[0:15], v[208:211], v[108:111], v[0:15]
    v_mfma_f32_32x32x16_bf16 v[16:31], v[212:215], v[108:111], v[16:31]
    v_mfma_f32_32x32x16_bf16 v[32:47], v[208:211], v[112:115], v[32:47]
    v_mfma_f32_32x32x16_bf16 v[48:63], v[212:215], v[112:115], v[48:63]
    v_mfma_f32_32x32x16_bf16 v[64:79], v[208:211], v[116:119], v[64:79]
    v_mfma_f32_32x32x16_bf16 v[80:95], v[212:215], v[116:119], v[80:95]
    buffer_load_dwordx4 v[108:111], v184, s[20:23], s40 offen sc1
    buffer_load_dwordx4 v[112:115], v184, s[20:23], s44 offen sc1
    buffer_load_dwordx4 v[116:119], v184, s[20:23], s45 offen sc1
    s_add_u32 s40, s40, 1024
    s_add_u32 s44, s44, 1024
    s_add_u32 s45, s45, 1024
    s_waitcnt vmcnt(15)
    v_mfma_f32_32x32x16_bf16 v[0:15], v[216:219], v[120:123], v[0:15]
    v_mfma_f32_32x32x16_bf16 v[16:31], v[220:223], v[120:123], v[16:31]
    v_mfma_f32_32x32x16_bf16 v[32:47], v[216:219], v[124:127], v[32:47]
    v_mfma_f32_32x32x16_bf16 v[48:63], v[220:223], v[124:127], v[48:63]
    v_mfma_f32_32x32x16_bf16 v[64:79], v[216:219], v[128:131], v[64:79]
    v_mfma_f32_32x32x16_bf16 v[80:95], v[220:223], v[128:131], v[80:95]
    buffer_load_dwordx4 v[120:123], v184, s[20:23], s40 offen sc1
    buffer_load_dwordx4 v[124:127], v184, s[20:23], s44 offen sc1
    buffer_load_dwordx4 v[128:131], v184, s[20:23], s45 offen sc1
    s_add_u32 s40, s40, 1024
    s_add_u32 s44, s44, 1024
    s_add_u32 s45, s45, 1024
    s_waitcnt vmcnt(15)
    v_mfma_f32_32x32x16_bf16 v[0:15], v[224:227], v[132:135], v[0:15]
    v_mfma_f32_32x32x16_bf16 v[16:31], v[228:231], v[132:135], v[16:31]
    v_mfma_f32_32x32x16_bf16 v[32:47], v[224:227], v[136:139], v[32:47]
    v_mfma_f32_32x32x16_bf16 v[48:63], v[228:231], v[136:139], v[48:63]
    v_mfma_f32_32x32x16_bf16 v[64:79], v[224:227], v[140:143], v[64:79]
    v_mfma_f32_32x32x16_bf16 v[80:95], v[228:231], v[140:143], v[80:95]
    buffer_load_dwordx4 v[132:135], v184, s[20:23], s40 offen sc1
    buffer_load_dwordx4 v[136:139], v184, s[20:23], s44 offen sc1
    buffer_load_dwordx4 v[140:143], v184, s[20:23], s45 offen sc1
    s_add_u32 s40, s40, 1024
    s_add_u32 s44, s44, 1024
    s_add_u32 s45, s45, 1024
    s_waitcnt vmcnt(15)
    v_mfma_f32_32x32x16_bf16 v[0:15], v[232:235], v[144:147], v[0:15]
    v_mfma_f32_32x32x16_bf16 v[16:31], v[236:239], v[144:147], v[16:31]
    v_mfma_f32_32x32x16_bf16 v[32:47], v[232:235], v[148:151], v[32:47]
    v_mfma_f32_32x32x16_bf16 v[48:63], v[236:239], v[148:151], v[48:63]
    v_mfma_f32_32x32x16_bf16 v[64:79], v[232:235], v[152:155], v[64:79]
    v_mfma_f32_32x32x16_bf16 v[80:95], v[236:239], v[152:155], v[80:95]
    buffer_load_dwordx4 v[144:147], v184, s[20:23], s40 offen sc1
    buffer_load_dwordx4 v[148:151], v184, s[20:23], s44 offen sc1
    buffer_load_dwordx4 v[152:155], v184, s[20:23], s45 offen sc1
    s_add_u32 s40, s40, 1024
    s_add_u32 s44, s44, 1024
    s_add_u32 s45, s45, 1024
    s_waitcnt vmcnt(15)
    v_mfma_f32_32x32x16_bf16 v[0:15], v[240:243], v[156:159], v[0:15]
    v_mfma_f32_32x32x16_bf16 v[16:31], v[244:247], v[156:159], v[16:31]
    v_mfma_f32_32x32x16_bf16 v[32:47], v[240:243], v[160:163], v[32:47]
    v_mfma_f32_32x32x16_bf16 v[48:63], v[244:247], v[160:163], v[48:63]
    v_mfma_f32_32x32x16_bf16 v[64:79], v[240:243], v[164:167], v[64:79]
    v_mfma_f32_32x32x16_bf16 v[80:95], v[244:247], v[164:167], v[80:95]
    buffer_load_dwordx4 v[156:159], v184, s[20:23], s40 offen sc1
    buffer_load_dwordx4 v[160:163], v184, s[20:23], s44 offen sc1
    buffer_load_dwordx4 v[164:167], v184, s[20:23], s45 offen sc1
    s_add_u32 s40, s40, 1024
    s_add_u32 s44, s44, 1024
    s_add_u32 s45, s45, 1024
    s_waitcnt vmcnt(15)
    ds_read_b64_tr_b16 v[176:177], v186 offset:14336
    ds_read_b64_tr_b16 v[178:179], v186 offset:14848
    ds_read_b64_tr_b16 v[180:181], v187 offset:14336
    ds_read_b64_tr_b16 v[182:183], v187 offset:14848
    v_mfma_f32_32x32x16_bf16 v[0:15], v[248:251], v[96:99], v[0:15]
    v_mfma_f32_32x32x16_bf16 v[16:31], v[252:255], v[96:99], v[16:31]
    v_mfma_f32_32x32x16_bf16 v[32:47], v[248:251], v[100:103], v[32:47]
    v_mfma_f32_32x32x16_bf16 v[48:63], v[252:255], v[100:103], v[48:63]
    v_mfma_f32_32x32x16_bf16 v[64:79], v[248:251], v[104:107], v[64:79]
    v_mfma_f32_32x32x16_bf16 v[80:95], v[252:255], v[104:107], v[80:95]
    buffer_load_dwordx4 v[96:99], v184, s[20:23], s40 offen sc1
    buffer_load_dwordx4 v[100:103], v184, s[20:23], s44 offen sc1
    buffer_load_dwordx4 v[104:107], v184, s[20:23], s45 offen sc1
    s_add_u32 s40, s40, 1024
    s_add_u32 s44, s44, 1024
    s_add_u32 s45, s45, 1024
    s_waitcnt vmcnt(15)
    ds_read_b64_tr_b16 v[168:169], v186 offset:16384
    ds_read_b64_tr_b16 v[170:171], v186 offset:16896
    ds_read_b64_tr_b16 v[172:173], v187 offset:16384
    ds_read_b64_tr_b16 v[174:175], v187 offset:16896
    s_waitcnt lgkmcnt(4)
    v_mfma_f32_32x32x16_bf16 v[0:15], v[176:179], v[108:111], v[0:15]
    v_mfma_f32_32x32x16_bf16 v[16:31], v[180:183], v[108:111], v[16:31]
    v_mfma_f32_32x32x16_bf16 v[32:47], v[176:179], v[112:115], v[32:47]
    v_mfma_f32_32x32x16_bf16 v[48:63], v[180:183], v[112:115], v[48:63]
    v_mfma_f32_32x32x16_bf16 v[64:79], v[176:179], v[116:119], v[64:79]
    v_mfma_f32_32x32x16_bf16 v[80:95], v[180:183], v[116:119], v[80:95]
    buffer_load_dwordx4 v[108:111], v184, s[20:23], s40 offen sc1
    buffer_load_dwordx4 v[112:115], v184, s[20:23], s44 offen sc1
    buffer_load_dwordx4 v[116:119], v184, s[20:23], s45 offen sc1
    s_add_u32 s40, s40, 1024
    s_add_u32 s44, s44, 1024
    s_add_u32 s45, s45, 1024
    s_add_u32 m0, s42, 14336
    s_add_u32 s33, s41, 20480
    buffer_load_dwordx4 v185, s[12:15], s41 offen lds
    buffer_load_dwordx4 v193, s[12:15], s41 offen offset:1024 lds
    s_mov_b32 s41, s33
    s_waitcnt vmcnt(17)
    ds_read_b64_tr_b16 v[176:177], v186 offset:18432
    ds_read_b64_tr_b16 v[178:179], v186 offset:18944
    ds_read_b64_tr_b16 v[180:181], v187 offset:18432
    ds_read_b64_tr_b16 v[182:183], v187 offset:18944
    s_waitcnt lgkmcnt(4)
    v_mfma_f32_32x32x16_bf16 v[0:15], v[168:171], v[120:123], v[0:15]
    v_mfma_f32_32x32x16_bf16 v[16:31], v[172:175], v[120:123], v[16:31]
    v_mfma_f32_32x32x16_bf16 v[32:47], v[168:171], v[124:127], v[32:47]
    v_mfma_f32_32x32x16_bf16 v[48:63], v[172:175], v[124:127], v[48:63]
    v_mfma_f32_32x32x16_bf16 v[64:79], v[168:171], v[128:131], v[64:79]
    v_mfma_f32_32x32x16_bf16 v[80:95], v[172:175], v[128:131], v[80:95]
    buffer_load_dwordx4 v[120:123], v184, s[20:23], s40 offen sc1
    buffer_load_dwordx4 v[124:127], v184, s[20:23], s44 offen sc1
    buffer_load_dwordx4 v[128:131], v184, s[20:23], s45 offen sc1
    s_add_u32 s40, s40, 1024
    s_add_u32 s44, s44, 1024
    s_add_u32 s45, s45, 1024
    s_add_u32 m0, s42, 16384
    s_add_u32 s33, s41, 20480
    buffer_load_dwordx4 v185, s[12:15], s41 offen lds
    buffer_load_dwordx4 v193, s[12:15], s41 offen offset:1024 lds
    s_mov_b32 s41, s33
    s_waitcnt vmcnt(19)
    ds_read_b64_tr_b16 v[168:169], v186 offset:20480
    ds_read_b64_tr_b16 v[170:171], v186 offset:20992
    ds_read_b64_tr_b16 v[172:173], v187 offset:20480
    ds_read_b64_tr_b16 v[174:175], v187 offset:20992
    s_waitcnt lgkmcnt(4)
    v_mfma_f32_32x32x16_bf16 v[0:15], v[176:179], v[132:135], v[0:15]
    v_mfma_f32_32x32x16_bf16 v[16:31], v[180:183], v[132:135], v[16:31]
    v_mfma_f32_32x32x16_bf16 v[32:47], v[176:179], v[136:139], v[32:47]
    v_mfma_f32_32x32x16_bf16 v[48:63], v[180:183], v[136:139], v[48:63]
    v_mfma_f32_32x32x16_bf16 v[64:79], v[176:179], v[140:143], v[64:79]
    v_mfma_f32_32x32x16_bf16 v[80:95], v[180:183], v[140:143], v[80:95]
    buffer_load_dwordx4 v[132:135], v184, s[20:23], s40 offen sc1
    buffer_load_dwordx4 v[136:139], v184, s[20:23], s44 offen sc1
    buffer_load_dwordx4 v[140:143], v184, s[20:23], s45 offen sc1
    s_add_u32 s40, s40, 1024
    s_add_u32 s44, s44, 1024
    s_add_u32 s45, s45, 1024
    s_add_u32 m0, s42, 18432
    s_add_u32 s33, s41, 20480
    buffer_load_dwordx4 v185, s[12:15], s41 offen lds
    buffer_load_dwordx4 v193, s[12:15], s41 offen offset:1024 lds
    s_mov_b32 s41, s33
    s_waitcnt vmcnt(21)
    ds_read_b64_tr_b16 v[176:177], v186 offset:22528
    ds_read_b64_tr_b16 v[178:179], v186 offset:23040
    ds_read_b64_tr_b16 v[180:181], v187 offset:22528
    ds_read_b64_tr_b16 v[182:183], v187 offset:23040
    s_waitcnt lgkmcnt(4)
    v_mfma_f32_32x32x16_bf16 v[0:15], v[168:171], v[144:147], v[0:15]
    v_mfma_f32_32x32x16_bf16 v[16:31], v[172:175], v[144:147], v[16:31]
    v_mfma_f32_32x32x16_bf16 v[32:47], v[168:171], v[148:151], v[32:47]
    v_mfma_f32_32x32x16_bf16 v[48:63], v[172:175], v[148:151], v[48:63]
    v_mfma_f32_32x32x16_bf16 v[64:79], v[168:171], v[152:155], v[64:79]
    v_mfma_f32_32x32x16_bf16 v[80:95], v[172:175], v[152:155], v[80:95]
    buffer_load_dwordx4 v[144:147], v184, s[20:23], s40 offen sc1
    buffer_load_dwordx4 v[148:151], v184, s[20:23], s44 offen sc1
    buffer_load_dwordx4 v[152:155], v184, s[20:23], s45 offen sc1
    s_add_u32 s40, s40, 1024
    s_add_u32 s44, s44, 1024
    s_add_u32 s45, s45, 1024
    s_add_u32 m0, s42, 20480
    s_add_u32 s33, s41, 20480
    buffer_load_dwordx4 v185, s[12:15], s41 offen lds
    buffer_load_dwordx4 v193, s[12:15], s41 offen offset:1024 lds
    s_mov_b32 s41, s33
    s_waitcnt vmcnt(23)
    ds_read_b64_tr_b16 v[168:169], v186 offset:0
    ds_read_b64_tr_b16 v[170:171], v186 offset:512
    ds_read_b64_tr_b16 v[172:173], v187 offset:0
    ds_read_b64_tr_b16 v[174:175], v187 offset:512
    s_waitcnt lgkmcnt(4)
    v_mfma_f32_32x32x16_bf16 v[0:15], v[176:179], v[156:159], v[0:15]
    v_mfma_f32_32x32x16_bf16 v[16:31], v[180:183], v[156:159], v[16:31]
    v_mfma_f32_32x32x16_bf16 v[32:47], v[176:179], v[160:163], v[32:47]
    v_mfma_f32_32x32x16_bf16 v[48:63], v[180:183], v[160:163], v[48:63]
    v_mfma_f32_32x32x16_bf16 v[64:79], v[176:179], v[164:167], v[64:79]
    v_mfma_f32_32x32x16_bf16 v[80:95], v[180:183], v[164:167], v[80:95]
    buffer_load_dwordx4 v[156:159], v184, s[20:23], s40 offen sc1
    buffer_load_dwordx4 v[160:163], v184, s[20:23], s44 offen sc1
    buffer_load_dwordx4 v[164:167], v184, s[20:23], s45 offen sc1
    s_add_u32 s40, s40, 1024
    s_add_u32 s44, s44, 1024
    s_add_u32 s45, s45, 1024
    s_add_u32 m0, s42, 22528
    s_add_u32 s33, s41, 20480
    buffer_load_dwordx4 v185, s[12:15], s41 offen lds
    buffer_load_dwordx4 v193, s[12:15], s41 offen offset:1024 lds
    s_mov_b32 s41, s33
    s_waitcnt vmcnt(25)
    ds_read_b64_tr_b16 v[176:177], v186 offset:2048
    ds_read_b64_tr_b16 v[178:179], v186 offset:2560
    ds_read_b64_tr_b16 v[180:181], v187 offset:2048
    ds_read_b64_tr_b16 v[182:183], v187 offset:2560
    s_waitcnt lgkmcnt(4)
    v_mfma_f32_32x32x16_bf16 v[0:15], v[168:171], v[96:99], v[0:15]
    v_mfma_f32_32x32x16_bf16 v[16:31], v[172:175], v[96:99], v[16:31]
    v_mfma_f32_32x32x16_bf16 v[32:47], v[168:171], v[100:103], v[32:47]
    v_mfma_f32_32x32x16_bf16 v[48:63], v[172:175], v[100:103], v[48:63]
    v_mfma_f32_32x32x16_bf16 v[64:79], v[168:171], v[104:107], v[64:79]
    v_mfma_f32_32x32x16_bf16 v[80:95], v[172:175], v[104:107], v[80:95]
    buffer_load_dwordx4 v[96:99], v184, s[20:23], s40 offen sc1
    buffer_load_dwordx4 v[100:103], v184, s[20:23], s44 offen sc1
    buffer_load_dwordx4 v[104:107], v184, s[20:23], s45 offen sc1
    s_add_u32 s40, s40, 1024
    s_add_u32 s44, s44, 1024
    s_add_u32 s45, s45, 1024
    s_mov_b32 s12, s64
    s_mov_b32 s13, s65
    s_mov_b32 s14, s66
    s_mul_i32 s6, s3, 204800
    s_lshl_b32 s7, s5, 7
    s_add_u32 s41, s6, s7
    s_add_u32 m0, s42, 0
    s_add_u32 s33, s41, 20480
    buffer_load_dwordx4 v185, s[12:15], s41 offen lds
    buffer_load_dwordx4 v193, s[12:15], s41 offen offset:1024 lds
    s_mov_b32 s41, s33
    s_waitcnt vmcnt(27)
    ds_read_b64_tr_b16 v[168:169], v186 offset:4096
    ds_read_b64_tr_b16 v[170:171], v186 offset:4608
    ds_read_b64_tr_b16 v[172:173], v187 offset:4096
    ds_read_b64_tr_b16 v[174:175], v187 offset:4608
    s_waitcnt lgkmcnt(4)
    v_mfma_f32_32x32x16_bf16 v[0:15], v[176:179], v[108:111], v[0:15]
    v_mfma_f32_32x32x16_bf16 v[16:31], v[180:183], v[108:111], v[16:31]
    v_mfma_f32_32x32x16_bf16 v[32:47], v[176:179], v[112:115], v[32:47]
    v_mfma_f32_32x32x16_bf16 v[48:63], v[180:183], v[112:115], v[48:63]
    v_mfma_f32_32x32x16_bf16 v[64:79], v[176:179], v[116:119], v[64:79]
    v_mfma_f32_32x32x16_bf16 v[80:95], v[180:183], v[116:119], v[80:95]
    s_mov_b64 exec, 0xff
    buffer_load_dword v195, v198, s[20:23], 0 offen sc1
    s_mov_b64 exec, -1
    buffer_load_dwordx4 v[108:111], v184, s[20:23], s40 offen sc1
    buffer_load_dwordx4 v[112:115], v184, s[20:23], s44 offen sc1
    buffer_load_dwordx4 v[116:119], v184, s[20:23], s45 offen sc1
    s_add_u32 s40, s40, 1024
    s_add_u32 s44, s44, 1024
    s_add_u32 s45, s45, 1024
    s_add_u32 m0, s42, 2048
    s_add_u32 s33, s41, 20480
    buffer_load_dwordx4 v185, s[12:15], s41 offen lds
    buffer_load_dwordx4 v193, s[12:15], s41 offen offset:1024 lds
    s_mov_b32 s41, s33
    s_waitcnt vmcnt(28)
    ds_read_b64_tr_b16 v[176:177], v186 offset:6144
    ds_read_b64_tr_b16 v[178:179], v186 offset:6656
    ds_read_b64_tr_b16 v[180:181], v187 offset:6144
    ds_read_b64_tr_b16 v[182:183], v187 offset:6656
    s_waitcnt lgkmcnt(4)
    v_mfma_f32_32x32x16_bf16 v[0:15], v[168:171], v[120:123], v[0:15]
    v_mfma_f32_32x32x16_bf16 v[16:31], v[172:175], v[120:123], v[16:31]
    v_mfma_f32_32x32x16_bf16 v[32:47], v[168:171], v[124:127], v[32:47]
    v_mfma_f32_32x32x16_bf16 v[48:63], v[172:175], v[124:127], v[48:63]
    v_mfma_f32_32x32x16_bf16 v[64:79], v[168:171], v[128:131], v[64:79]
    v_mfma_f32_32x32x16_bf16 v[80:95], v[172:175], v[128:131], v[80:95]
    buffer_load_dwordx4 v[120:123], v184, s[20:23], s40 offen sc1
    buffer_load_dwordx4 v[124:127], v184, s[20:23], s44 offen sc1
    buffer_load_dwordx4 v[128:131], v184, s[20:23], s45 offen sc1
    s_add_u32 s40, s40, 1024
    s_add_u32 s44, s44, 1024
    s_add_u32 s45, s45, 1024
    s_add_u32 m0, s42, 4096
    s_add_u32 s33, s41, 20480
    buffer_load_dwordx4 v185, s[12:15], s41 offen lds
    buffer_load_dwordx4 v193, s[12:15], s41 offen offset:1024 lds
    s_mov_b32 s41, s33
    s_waitcnt vmcnt(28)
    ds_read_b64_tr_b16 v[168:169], v186 offset:8192
    ds_read_b64_tr_b16 v[170:171], v186 offset:8704
    ds_read_b64_tr_b16 v[172:173], v187 offset:8192
    ds_read_b64_tr_b16 v[174:175], v187 offset:8704
    s_waitcnt lgkmcnt(4)
    v_mfma_f32_32x32x16_bf16 v[0:15], v[176:179], v[132:135], v[0:15]
    v_mfma_f32_32x32x16_bf16 v[16:31], v[180:183], v[132:135], v[16:31]
    v_mfma_f32_32x32x16_bf16 v[32:47], v[176:179], v[136:139], v[32:47]
    v_mfma_f32_32x32x16_bf16 v[48:63], v[180:183], v[136:139], v[48:63]
    v_mfma_f32_32x32x16_bf16 v[64:79], v[176:179], v[140:143], v[64:79]
    v_mfma_f32_32x32x16_bf16 v[80:95], v[180:183], v[140:143], v[80:95]
    buffer_load_dwordx4 v[132:135], v184, s[20:23], s40 offen sc1
    buffer_load_dwordx4 v[136:139], v184, s[20:23], s44 offen sc1
    buffer_load_dwordx4 v[140:143], v184, s[20:23], s45 offen sc1
    s_add_u32 s40, s40, 1024
    s_add_u32 s44, s44, 1024
    s_add_u32 s45, s45, 1024
    s_add_u32 m0, s42, 6144
    s_add_u32 s33, s41, 20480
    buffer_load_dwordx4 v185, s[12:15], s41 offen lds
    buffer_load_dwordx4 v193, s[12:15], s41 offen offset:1024 lds
    s_mov_b32 s41, s33
    s_waitcnt vmcnt(28)
    ds_read_b64_tr_b16 v[176:177], v186 offset:10240
    ds_read_b64_tr_b16 v[178:179], v186 offset:10752
    ds_read_b64_tr_b16 v[180:181], v187 offset:10240
    ds_read_b64_tr_b16 v[182:183], v187 offset:10752
    s_waitcnt lgkmcnt(4)
    v_mfma_f32_32x32x16_bf16 v[0:15], v[168:171], v[144:147], v[0:15]
    v_mfma_f32_32x32x16_bf16 v[16:31], v[172:175], v[144:147], v[16:31]
    v_mfma_f32_32x32x16_bf16 v[32:47], v[168:171], v[148:151], v[32:47]
    v_mfma_f32_32x32x16_bf16 v[48:63], v[172:175], v[148:151], v[48:63]
    v_mfma_f32_32x32x16_bf16 v[64:79], v[168:171], v[152:155], v[64:79]
    v_mfma_f32_32x32x16_bf16 v[80:95], v[172:175], v[152:155], v[80:95]
    buffer_load_dwordx4 v[144:147], v184, s[20:23], s40 offen sc1
    buffer_load_dwordx4 v[148:151], v184, s[20:23], s44 offen sc1
    buffer_load_dwordx4 v[152:155], v184, s[20:23], s45 offen sc1
    s_add_u32 s40, s40, 1024
    s_add_u32 s44, s44, 1024
    s_add_u32 s45, s45, 1024
    s_add_u32 m0, s42, 8192
    s_add_u32 s33, s41, 20480
    buffer_load_dwordx4 v185, s[12:15], s41 offen lds
    buffer_load_dwordx4 v193, s[12:15], s41 offen offset:1024 lds
    s_mov_b32 s41, s33
    s_waitcnt vmcnt(28)
    ds_read_b64_tr_b16 v[168:169], v186 offset:12288
    ds_read_b64_tr_b16 v[170:171], v186 offset:12800
    ds_read_b64_tr_b16 v[172:173], v187 offset:12288
    ds_read_b64_tr_b16 v[174:175], v187 offset:12800
    s_waitcnt lgkmcnt(4)
    v_mfma_f32_32x32x16_bf16 v[0:15], v[176:179], v[156:159], v[0:15]
    v_mfma_f32_32x32x16_bf16 v[16:31], v[180:183], v[156:159], v[16:31]
    v_mfma_f32_32x32x16_bf16 v[32:47], v[176:179], v[160:163], v[32:47]
    v_mfma_f32_32x32x16_bf16 v[48:63], v[180:183], v[160:163], v[48:63]
    v_mfma_f32_32x32x16_bf16 v[64:79], v[176:179], v[164:167], v[64:79]
    v_mfma_f32_32x32x16_bf16 v[80:95], v[180:183], v[164:167], v[80:95]
    buffer_load_dwordx4 v[156:159], v184, s[20:23], s40 offen sc1
    buffer_load_dwordx4 v[160:163], v184, s[20:23], s44 offen sc1
    buffer_load_dwordx4 v[164:167], v184, s[20:23], s45 offen sc1
    s_add_u32 s40, s40, 1024
    s_add_u32 s44, s44, 1024
    s_add_u32 s45, s45, 1024
    s_add_u32 m0, s42, 10240
    s_add_u32 s33, s41, 20480
    buffer_load_dwordx4 v185, s[12:15], s41 offen lds
    buffer_load_dwordx4 v193, s[12:15], s41 offen offset:1024 lds
    s_mov_b32 s41, s33
    s_waitcnt vmcnt(28)
    ds_read_b64_tr_b16 v[176:177], v186 offset:14336
    ds_read_b64_tr_b16 v[178:179], v186 offset:14848
    ds_read_b64_tr_b16 v[180:181], v187 offset:14336
    ds_read_b64_tr_b16 v[182:183], v187 offset:14848
    s_waitcnt lgkmcnt(4)
    v_mfma_f32_32x32x16_bf16 v[0:15], v[168:171], v[96:99], v[0:15]
    v_mfma_f32_32x32x16_bf16 v[16:31], v[172:175], v[96:99], v[16:31]
    v_mfma_f32_32x32x16_bf16 v[32:47], v[168:171], v[100:103], v[32:47]
    v_mfma_f32_32x32x16_bf16 v[48:63], v[172:175], v[100:103], v[48:63]
    v_mfma_f32_32x32x16_bf16 v[64:79], v[168:171], v[104:107], v[64:79]
    v_mfma_f32_32x32x16_bf16 v[80:95], v[172:175], v[104:107], v[80:95]
    s_waitcnt vmcnt(25)
    s_mov_b64 exec, 0xff
    v_cmp_ne_u32 vcc, s94, v195
    s_mov_b64 exec, -1
    s_cbranch_vccz parallel_sum__sliding_block__dense_activation_gelu__prompt_kernel_g_ook
    s_mov_b64 exec, 0xff
    s_mov_b32 s34, 0
    buffer_load_dword v197, v198, s[20:23], 0 offen sc1
    s_sleep 2
parallel_sum__sliding_block__dense_activation_gelu__prompt_kernel_g_po:
    buffer_load_dword v199, v198, s[20:23], 0 offen sc1
    s_waitcnt vmcnt(1)
    v_cmp_ne_u32 vcc, s94, v197
    s_cbranch_vccz parallel_sum__sliding_block__dense_activation_gelu__prompt_kernel_g_po_ok
    s_sleep 1
    buffer_load_dword v197, v198, s[20:23], 0 offen sc1
    s_waitcnt vmcnt(1)
    v_cmp_ne_u32 vcc, s94, v199
    s_cbranch_vccz parallel_sum__sliding_block__dense_activation_gelu__prompt_kernel_g_po_ok
    s_sleep 1
    s_add_u32 s34, s34, 1
    s_cmp_lt_u32 s34, 100000
    s_cbranch_scc1 parallel_sum__sliding_block__dense_activation_gelu__prompt_kernel_g_po
parallel_sum__sliding_block__dense_activation_gelu__prompt_kernel_g_po_ok:
    s_mov_b64 exec, -1
parallel_sum__sliding_block__dense_activation_gelu__prompt_kernel_g_ook:
    s_mul_i32 s6, s3, 10
    s_mul_i32 s7, s4, 408
    s_add_u32 s6, s6, s7
    s_lshl_b32 s40, s6, 10
    s_add_u32 s40, s40, 0
    s_add_u32 s44, s40, 139264
    s_add_u32 s45, s40, 278528
    buffer_load_dwordx4 v[96:99], v184, s[20:23], s40 offen sc1
    buffer_load_dwordx4 v[100:103], v184, s[20:23], s44 offen sc1
    buffer_load_dwordx4 v[104:107], v184, s[20:23], s45 offen sc1
    s_add_u32 s40, s40, 1024
    s_add_u32 s44, s44, 1024
    s_add_u32 s45, s45, 1024
    s_add_u32 m0, s42, 12288
    s_add_u32 s33, s41, 20480
    buffer_load_dwordx4 v185, s[12:15], s41 offen lds
    buffer_load_dwordx4 v193, s[12:15], s41 offen offset:1024 lds
    s_mov_b32 s41, s33
    s_waitcnt vmcnt(27)
    ds_read_b64_tr_b16 v[168:169], v186 offset:16384
    ds_read_b64_tr_b16 v[170:171], v186 offset:16896
    ds_read_b64_tr_b16 v[172:173], v187 offset:16384
    ds_read_b64_tr_b16 v[174:175], v187 offset:16896
    s_waitcnt lgkmcnt(4)
    v_mfma_f32_32x32x16_bf16 v[0:15], v[176:179], v[108:111], v[0:15]
    v_mfma_f32_32x32x16_bf16 v[16:31], v[180:183], v[108:111], v[16:31]
    v_mfma_f32_32x32x16_bf16 v[32:47], v[176:179], v[112:115], v[32:47]
    v_mfma_f32_32x32x16_bf16 v[48:63], v[180:183], v[112:115], v[48:63]
    v_mfma_f32_32x32x16_bf16 v[64:79], v[176:179], v[116:119], v[64:79]
    v_mfma_f32_32x32x16_bf16 v[80:95], v[180:183], v[116:119], v[80:95]
    buffer_load_dwordx4 v[108:111], v184, s[20:23], s40 offen sc1
    buffer_load_dwordx4 v[112:115], v184, s[20:23], s44 offen sc1
    buffer_load_dwordx4 v[116:119], v184, s[20:23], s45 offen sc1
    s_add_u32 s40, s40, 1024
    s_add_u32 s44, s44, 1024
    s_add_u32 s45, s45, 1024
    s_add_u32 m0, s42, 14336
    s_add_u32 s33, s41, 20480
    buffer_load_dwordx4 v185, s[12:15], s41 offen lds
    buffer_load_dwordx4 v193, s[12:15], s41 offen offset:1024 lds
    s_mov_b32 s41, s33
    s_waitcnt vmcnt(27)
    ds_read_b64_tr_b16 v[176:177], v186 offset:18432
    ds_read_b64_tr_b16 v[178:179], v186 offset:18944
    ds_read_b64_tr_b16 v[180:181], v187 offset:18432
    ds_read_b64_tr_b16 v[182:183], v187 offset:18944
    s_waitcnt lgkmcnt(4)
    v_mfma_f32_32x32x16_bf16 v[0:15], v[168:171], v[120:123], v[0:15]
    v_mfma_f32_32x32x16_bf16 v[16:31], v[172:175], v[120:123], v[16:31]
    v_mfma_f32_32x32x16_bf16 v[32:47], v[168:171], v[124:127], v[32:47]
    v_mfma_f32_32x32x16_bf16 v[48:63], v[172:175], v[124:127], v[48:63]
    v_mfma_f32_32x32x16_bf16 v[64:79], v[168:171], v[128:131], v[64:79]
    v_mfma_f32_32x32x16_bf16 v[80:95], v[172:175], v[128:131], v[80:95]
    buffer_load_dwordx4 v[120:123], v184, s[20:23], s40 offen sc1
    buffer_load_dwordx4 v[124:127], v184, s[20:23], s44 offen sc1
    buffer_load_dwordx4 v[128:131], v184, s[20:23], s45 offen sc1
    s_add_u32 s40, s40, 1024
    s_add_u32 s44, s44, 1024
    s_add_u32 s45, s45, 1024
    s_add_u32 m0, s42, 16384
    s_add_u32 s33, s41, 20480
    buffer_load_dwordx4 v185, s[12:15], s41 offen lds
    buffer_load_dwordx4 v193, s[12:15], s41 offen offset:1024 lds
    s_mov_b32 s41, s33
    s_waitcnt vmcnt(27)
    ds_read_b64_tr_b16 v[168:169], v186 offset:20480
    ds_read_b64_tr_b16 v[170:171], v186 offset:20992
    ds_read_b64_tr_b16 v[172:173], v187 offset:20480
    ds_read_b64_tr_b16 v[174:175], v187 offset:20992
    s_waitcnt lgkmcnt(4)
    v_mfma_f32_32x32x16_bf16 v[0:15], v[176:179], v[132:135], v[0:15]
    v_mfma_f32_32x32x16_bf16 v[16:31], v[180:183], v[132:135], v[16:31]
    v_mfma_f32_32x32x16_bf16 v[32:47], v[176:179], v[136:139], v[32:47]
    v_mfma_f32_32x32x16_bf16 v[48:63], v[180:183], v[136:139], v[48:63]
    v_mfma_f32_32x32x16_bf16 v[64:79], v[176:179], v[140:143], v[64:79]
    v_mfma_f32_32x32x16_bf16 v[80:95], v[180:183], v[140:143], v[80:95]
    buffer_load_dwordx4 v[132:135], v184, s[20:23], s40 offen sc1
    buffer_load_dwordx4 v[136:139], v184, s[20:23], s44 offen sc1
    buffer_load_dwordx4 v[140:143], v184, s[20:23], s45 offen sc1
    s_add_u32 s40, s40, 1024
    s_add_u32 s44, s44, 1024
    s_add_u32 s45, s45, 1024
    s_add_u32 m0, s42, 18432
    s_add_u32 s33, s41, 20480
    buffer_load_dwordx4 v185, s[12:15], s41 offen lds
    buffer_load_dwordx4 v193, s[12:15], s41 offen offset:1024 lds
    s_mov_b32 s41, s33
    s_waitcnt vmcnt(27)
    ds_read_b64_tr_b16 v[176:177], v186 offset:22528
    ds_read_b64_tr_b16 v[178:179], v186 offset:23040
    ds_read_b64_tr_b16 v[180:181], v187 offset:22528
    ds_read_b64_tr_b16 v[182:183], v187 offset:23040
    s_waitcnt lgkmcnt(4)
    v_mfma_f32_32x32x16_bf16 v[0:15], v[168:171], v[144:147], v[0:15]
    v_mfma_f32_32x32x16_bf16 v[16:31], v[172:175], v[144:147], v[16:31]
    v_mfma_f32_32x32x16_bf16 v[32:47], v[168:171], v[148:151], v[32:47]
    v_mfma_f32_32x32x16_bf16 v[48:63], v[172:175], v[148:151], v[48:63]
    v_mfma_f32_32x32x16_bf16 v[64:79], v[168:171], v[152:155], v[64:79]
    v_mfma_f32_32x32x16_bf16 v[80:95], v[172:175], v[152:155], v[80:95]
    buffer_load_dwordx4 v[144:147], v184, s[20:23], s40 offen sc1
    buffer_load_dwordx4 v[148:151], v184, s[20:23], s44 offen sc1
    buffer_load_dwordx4 v[152:155], v184, s[20:23], s45 offen sc1
    s_add_u32 s40, s40, 1024
    s_add_u32 s44, s44, 1024
    s_add_u32 s45, s45, 1024
    s_waitcnt vmcnt(25)
    ds_read_b64_tr_b16 v[168:169], v186 offset:0
    ds_read_b64_tr_b16 v[170:171], v186 offset:512
    ds_read_b64_tr_b16 v[172:173], v187 offset:0
    ds_read_b64_tr_b16 v[174:175], v187 offset:512
    s_waitcnt lgkmcnt(4)
    v_mfma_f32_32x32x16_bf16 v[0:15], v[176:179], v[156:159], v[0:15]
    v_mfma_f32_32x32x16_bf16 v[16:31], v[180:183], v[156:159], v[16:31]
    v_mfma_f32_32x32x16_bf16 v[32:47], v[176:179], v[160:163], v[32:47]
    v_mfma_f32_32x32x16_bf16 v[48:63], v[180:183], v[160:163], v[48:63]
    v_mfma_f32_32x32x16_bf16 v[64:79], v[176:179], v[164:167], v[64:79]
    v_mfma_f32_32x32x16_bf16 v[80:95], v[180:183], v[164:167], v[80:95]
    buffer_load_dwordx4 v[156:159], v184, s[20:23], s40 offen sc1
    buffer_load_dwordx4 v[160:163], v184, s[20:23], s44 offen sc1
    buffer_load_dwordx4 v[164:167], v184, s[20:23], s45 offen sc1
    s_add_u32 s40, s40, 1024
    s_add_u32 s44, s44, 1024
    s_add_u32 s45, s45, 1024
    s_waitcnt vmcnt(23)
    ds_read_b64_tr_b16 v[176:177], v186 offset:2048
    ds_read_b64_tr_b16 v[178:179], v186 offset:2560
    ds_read_b64_tr_b16 v[180:181], v187 offset:2048
    ds_read_b64_tr_b16 v[182:183], v187 offset:2560
    s_waitcnt lgkmcnt(4)
    v_mfma_f32_32x32x16_bf16 v[0:15], v[168:171], v[96:99], v[0:15]
    v_mfma_f32_32x32x16_bf16 v[16:31], v[172:175], v[96:99], v[16:31]
    v_mfma_f32_32x32x16_bf16 v[32:47], v[168:171], v[100:103], v[32:47]
    v_mfma_f32_32x32x16_bf16 v[48:63], v[172:175], v[100:103], v[48:63]
    v_mfma_f32_32x32x16_bf16 v[64:79], v[168:171], v[104:107], v[64:79]
    v_mfma_f32_32x32x16_bf16 v[80:95], v[172:175], v[104:107], v[80:95]
    buffer_load_dwordx4 v[96:99], v184, s[20:23], s40 offen sc1
    buffer_load_dwordx4 v[100:103], v184, s[20:23], s44 offen sc1
    buffer_load_dwordx4 v[104:107], v184, s[20:23], s45 offen sc1
    s_add_u32 s40, s40, 1024
    s_add_u32 s44, s44, 1024
    s_add_u32 s45, s45, 1024
    s_waitcnt vmcnt(21)
    ds_read_b64_tr_b16 v[168:169], v186 offset:4096
    ds_read_b64_tr_b16 v[170:171], v186 offset:4608
    ds_read_b64_tr_b16 v[172:173], v187 offset:4096
    ds_read_b64_tr_b16 v[174:175], v187 offset:4608
    s_waitcnt lgkmcnt(4)
    v_mfma_f32_32x32x16_bf16 v[0:15], v[176:179], v[108:111], v[0:15]
    v_mfma_f32_32x32x16_bf16 v[16:31], v[180:183], v[108:111], v[16:31]
    v_mfma_f32_32x32x16_bf16 v[32:47], v[176:179], v[112:115], v[32:47]
    v_mfma_f32_32x32x16_bf16 v[48:63], v[180:183], v[112:115], v[48:63]
    v_mfma_f32_32x32x16_bf16 v[64:79], v[176:179], v[116:119], v[64:79]
    v_mfma_f32_32x32x16_bf16 v[80:95], v[180:183], v[116:119], v[80:95]
    buffer_load_dwordx4 v[108:111], v184, s[20:23], s40 offen sc1
    buffer_load_dwordx4 v[112:115], v184, s[20:23], s44 offen sc1
    buffer_load_dwordx4 v[116:119], v184, s[20:23], s45 offen sc1
    s_add_u32 s40, s40, 1024
    s_add_u32 s44, s44, 1024
    s_add_u32 s45, s45, 1024
    s_waitcnt vmcnt(19)
    ds_read_b64_tr_b16 v[176:177], v186 offset:6144
    ds_read_b64_tr_b16 v[178:179], v186 offset:6656
    ds_read_b64_tr_b16 v[180:181], v187 offset:6144
    ds_read_b64_tr_b16 v[182:183], v187 offset:6656
    s_waitcnt lgkmcnt(4)
    v_mfma_f32_32x32x16_bf16 v[0:15], v[168:171], v[120:123], v[0:15]
    v_mfma_f32_32x32x16_bf16 v[16:31], v[172:175], v[120:123], v[16:31]
    v_mfma_f32_32x32x16_bf16 v[32:47], v[168:171], v[124:127], v[32:47]
    v_mfma_f32_32x32x16_bf16 v[48:63], v[172:175], v[124:127], v[48:63]
    v_mfma_f32_32x32x16_bf16 v[64:79], v[168:171], v[128:131], v[64:79]
    v_mfma_f32_32x32x16_bf16 v[80:95], v[172:175], v[128:131], v[80:95]
    buffer_load_dwordx4 v[120:123], v184, s[20:23], s40 offen sc1
    buffer_load_dwordx4 v[124:127], v184, s[20:23], s44 offen sc1
    buffer_load_dwordx4 v[128:131], v184, s[20:23], s45 offen sc1
    s_add_u32 s40, s40, 1024
    s_add_u32 s44, s44, 1024
    s_add_u32 s45, s45, 1024
    s_and_b32 s6, s3, 1
    s_lshl_b32 s6, s6, 6
    s_lshr_b32 s7, s3, 1
    s_lshl_b32 s7, s7, 5
    s_add_u32 s6, s6, s7
    s_lshl_b32 s7, s5, 7
    s_add_u32 s6, s6, s7
    v_lshlrev_b32 v216, 4, v189
    v_add_u32 v216, s6, v216
    buffer_load_dwordx4 v[200:203], v216, s[24:27], 0 offen
    s_mul_i32 s6, s4, 96
    v_add_u32 v217, s6, v188
    v_mul_u32_u24 v217, 1280, v217
    v_add_u32 v217, v217, v216
    v_add_u32 v218, 40960, v217
    v_add_u32 v219, 81920, v217
    buffer_load_dwordx4 v[204:207], v217, s[8:11], 0 offen
    buffer_load_dwordx4 v[208:211], v218, s[8:11], 0 offen
    buffer_load_dwordx4 v[212:215], v219, s[8:11], 0 offen
    s_waitcnt vmcnt(21)
    ds_read_b64_tr_b16 v[168:169], v186 offset:8192
    ds_read_b64_tr_b16 v[170:171], v186 offset:8704
    ds_read_b64_tr_b16 v[172:173], v187 offset:8192
    ds_read_b64_tr_b16 v[174:175], v187 offset:8704
    s_waitcnt lgkmcnt(4)
    v_mfma_f32_32x32x16_bf16 v[0:15], v[176:179], v[132:135], v[0:15]
    v_mfma_f32_32x32x16_bf16 v[16:31], v[180:183], v[132:135], v[16:31]
    v_mfma_f32_32x32x16_bf16 v[32:47], v[176:179], v[136:139], v[32:47]
    v_mfma_f32_32x32x16_bf16 v[48:63], v[180:183], v[136:139], v[48:63]
    v_mfma_f32_32x32x16_bf16 v[64:79], v[176:179], v[140:143], v[64:79]
    v_mfma_f32_32x32x16_bf16 v[80:95], v[180:183], v[140:143], v[80:95]
    buffer_load_dwordx4 v[132:135], v184, s[20:23], s40 offen sc1
    buffer_load_dwordx4 v[136:139], v184, s[20:23], s44 offen sc1
    buffer_load_dwordx4 v[140:143], v184, s[20:23], s45 offen sc1
    s_add_u32 s40, s40, 1024
    s_add_u32 s44, s44, 1024
    s_add_u32 s45, s45, 1024
    s_waitcnt vmcnt(19)
    ds_read_b64_tr_b16 v[176:177], v186 offset:10240
    ds_read_b64_tr_b16 v[178:179], v186 offset:10752
    ds_read_b64_tr_b16 v[180:181], v187 offset:10240
    ds_read_b64_tr_b16 v[182:183], v187 offset:10752
    s_waitcnt lgkmcnt(4)
    v_mfma_f32_32x32x16_bf16 v[0:15], v[168:171], v[144:147], v[0:15]
    v_mfma_f32_32x32x16_bf16 v[16:31], v[172:175], v[144:147], v[16:31]
    v_mfma_f32_32x32x16_bf16 v[32:47], v[168:171], v[148:151], v[32:47]
    v_mfma_f32_32x32x16_bf16 v[48:63], v[172:175], v[148:151], v[48:63]
    v_mfma_f32_32x32x16_bf16 v[64:79], v[168:171], v[152:155], v[64:79]
    v_mfma_f32_32x32x16_bf16 v[80:95], v[172:175], v[152:155], v[80:95]
    s_waitcnt vmcnt(16)
    ds_read_b64_tr_b16 v[168:169], v186 offset:12288
    ds_read_b64_tr_b16 v[170:171], v186 offset:12800
    ds_read_b64_tr_b16 v[172:173], v187 offset:12288
    ds_read_b64_tr_b16 v[174:175], v187 offset:12800
    s_waitcnt lgkmcnt(4)
    v_mfma_f32_32x32x16_bf16 v[0:15], v[176:179], v[156:159], v[0:15]
    v_mfma_f32_32x32x16_bf16 v[16:31], v[180:183], v[156:159], v[16:31]
    v_mfma_f32_32x32x16_bf16 v[32:47], v[176:179], v[160:163], v[32:47]
    v_mfma_f32_32x32x16_bf16 v[48:63], v[180:183], v[160:163], v[48:63]
    v_mfma_f32_32x32x16_bf16 v[64:79], v[176:179], v[164:167], v[64:79]
    v_mfma_f32_32x32x16_bf16 v[80:95], v[180:183], v[164:167], v[80:95]
    s_waitcnt vmcnt(13)
    ds_read_b64_tr_b16 v[176:177], v186 offset:14336
    ds_read_b64_tr_b16 v[178:179], v186 offset:14848
    ds_read_b64_tr_b16 v[180:181], v187 offset:14336
    ds_read_b64_tr_b16 v[182:183], v187 offset:14848
    s_waitcnt lgkmcnt(4)
    v_mfma_f32_32x32x16_bf16 v[0:15], v[168:171], v[96:99], v[0:15]
    v_mfma_f32_32x32x16_bf16 v[16:31], v[172:175], v[96:99], v[16:31]
    v_mfma_f32_32x32x16_bf16 v[32:47], v[168:171], v[100:103], v[32:47]
    v_mfma_f32_32x32x16_bf16 v[48:63], v[172:175], v[100:103], v[48:63]
    v_mfma_f32_32x32x16_bf16 v[64:79], v[168:171], v[104:107], v[64:79]
    v_mfma_f32_32x32x16_bf16 v[80:95], v[172:175], v[104:107], v[80:95]
    s_waitcnt vmcnt(10)
    ds_read_b64_tr_b16 v[168:169], v186 offset:16384
    ds_read_b64_tr_b16 v[170:171], v186 offset:16896
    ds_read_b64_tr_b16 v[172:173], v187 offset:16384
    ds_read_b64_tr_b16 v[174:175], v187 offset:16896
    s_waitcnt lgkmcnt(4)
    v_mfma_f32_32x32x16_bf16 v[0:15], v[176:179], v[108:111], v[0:15]
    v_mfma_f32_32x32x16_bf16 v[16:31], v[180:183], v[108:111], v[16:31]
    v_mfma_f32_32x32x16_bf16 v[32:47], v[176:179], v[112:115], v[32:47]
    v_mfma_f32_32x32x16_bf16 v[48:63], v[180:183], v[112:115], v[48:63]
    v_mfma_f32_32x32x16_bf16 v[64:79], v[176:179], v[116:119], v[64:79]
    v_mfma_f32_32x32x16_bf16 v[80:95], v[180:183], v[116:119], v[80:95]
    s_waitcnt vmcnt(7)
    ds_read_b64_tr_b16 v[176:177], v186 offset:18432
    ds_read_b64_tr_b16 v[178:179], v186 offset:18944
    ds_read_b64_tr_b16 v[180:181], v187 offset:18432
    ds_read_b64_tr_b16 v[182:183], v187 offset:18944
    s_waitcnt lgkmcnt(4)
    v_mfma_f32_32x32x16_bf16 v[0:15], v[168:171], v[120:123], v[0:15]
    v_mfma_f32_32x32x16_bf16 v[16:31], v[172:175], v[120:123], v[16:31]
    v_mfma_f32_32x32x16_bf16 v[32:47], v[168:171], v[124:127], v[32:47]
    v_mfma_f32_32x32x16_bf16 v[48:63], v[172:175], v[124:127], v[48:63]
    v_mfma_f32_32x32x16_bf16 v[64:79], v[168:171], v[128:131], v[64:79]
    v_mfma_f32_32x32x16_bf16 v[80:95], v[172:175], v[128:131], v[80:95]
    s_waitcnt vmcnt(0)
    s_waitcnt lgkmcnt(0)
    v_mfma_f32_32x32x16_bf16 v[0:15], v[176:179], v[132:135], v[0:15]
    v_mfma_f32_32x32x16_bf16 v[16:31], v[180:183], v[132:135], v[16:31]
    v_mfma_f32_32x32x16_bf16 v[32:47], v[176:179], v[136:139], v[32:47]
    v_mfma_f32_32x32x16_bf16 v[48:63], v[180:183], v[136:139], v[48:63]
    v_mfma_f32_32x32x16_bf16 v[64:79], v[176:179], v[140:143], v[64:79]
    v_mfma_f32_32x32x16_bf16 v[80:95], v[180:183], v[140:143], v[80:95]
    v_lshl_add_u32 v190, v189, 5, v188
    v_lshlrev_b32 v190, 4, v190
    v_add_u32 v191, s42, v190
    s_cmp_lg_u32 s3, 0
    s_cbranch_scc1 parallel_sum__sliding_block__dense_activation_gelu__prompt_kernel_red1
    ds_write_b128 v191, v[16:19] offset:0
    ds_write_b128 v191, v[20:23] offset:1024
    ds_write_b128 v191, v[48:51] offset:2048
    ds_write_b128 v191, v[52:55] offset:3072
    ds_write_b128 v191, v[80:83] offset:4096
    ds_write_b128 v191, v[84:87] offset:5120
    ds_write_b128 v191, v[8:11] offset:6144
    ds_write_b128 v191, v[12:15] offset:7168
    ds_write_b128 v191, v[40:43] offset:8192
    ds_write_b128 v191, v[44:47] offset:9216
    ds_write_b128 v191, v[72:75] offset:10240
    ds_write_b128 v191, v[76:79] offset:11264
    ds_write_b128 v191, v[24:27] offset:12288
    ds_write_b128 v191, v[28:31] offset:13312
    ds_write_b128 v191, v[56:59] offset:14336
    ds_write_b128 v191, v[60:63] offset:15360
    ds_write_b128 v191, v[88:91] offset:16384
    ds_write_b128 v191, v[92:95] offset:17408
    v_pk_mov_b32 v[96:97], v[0:1], v[0:1] op_sel:[0,1]
    v_pk_mov_b32 v[98:99], v[2:3], v[2:3] op_sel:[0,1]
    v_pk_mov_b32 v[100:101], v[4:5], v[4:5] op_sel:[0,1]
    v_pk_mov_b32 v[102:103], v[6:7], v[6:7] op_sel:[0,1]
    v_pk_mov_b32 v[104:105], v[32:33], v[32:33] op_sel:[0,1]
    v_pk_mov_b32 v[106:107], v[34:35], v[34:35] op_sel:[0,1]
    v_pk_mov_b32 v[108:109], v[36:37], v[36:37] op_sel:[0,1]
    v_pk_mov_b32 v[110:111], v[38:39], v[38:39] op_sel:[0,1]
    v_pk_mov_b32 v[112:113], v[64:65], v[64:65] op_sel:[0,1]
    v_pk_mov_b32 v[114:115], v[66:67], v[66:67] op_sel:[0,1]
    v_pk_mov_b32 v[116:117], v[68:69], v[68:69] op_sel:[0,1]
    v_pk_mov_b32 v[118:119], v[70:71], v[70:71] op_sel:[0,1]
    v_add_u32 v192, 24576, v190
    v_add_u32 v193, 49152, v190
    v_add_u32 v194, 73728, v190
    s_branch parallel_sum__sliding_block__dense_activation_gelu__prompt_kernel_redc
parallel_sum__sliding_block__dense_activation_gelu__prompt_kernel_red1:
    s_cmp_lg_u32 s3, 1
    s_cbranch_scc1 parallel_sum__sliding_block__dense_activation_gelu__prompt_kernel_red2
    ds_write_b128 v191, v[0:3] offset:0
    ds_write_b128 v191, v[4:7] offset:1024
    ds_write_b128 v191, v[32:35] offset:2048
    ds_write_b128 v191, v[36:39] offset:3072
    ds_write_b128 v191, v[64:67] offset:4096
    ds_write_b128 v191, v[68:71] offset:5120
    ds_write_b128 v191, v[8:11] offset:6144
    ds_write_b128 v191, v[12:15] offset:7168
    ds_write_b128 v191, v[40:43] offset:8192
    ds_write_b128 v191, v[44:47] offset:9216
    ds_write_b128 v191, v[72:75] offset:10240
    ds_write_b128 v191, v[76:79] offset:11264
    ds_write_b128 v191, v[24:27] offset:12288
    ds_write_b128 v191, v[28:31] offset:13312
    ds_write_b128 v191, v[56:59] offset:14336
    ds_write_b128 v191, v[60:63] offset:15360
    ds_write_b128 v191, v[88:91] offset:16384
    ds_write_b128 v191, v[92:95] offset:17408
    v_pk_mov_b32 v[96:97], v[16:17], v[16:17] op_sel:[0,1]
    v_pk_mov_b32 v[98:99], v[18:19], v[18:19] op_sel:[0,1]
    v_pk_mov_b32 v[100:101], v[20:21], v[20:21] op_sel:[0,1]
    v_pk_mov_b32 v[102:103], v[22:23], v[22:23] op_sel:[0,1]
    v_pk_mov_b32 v[104:105], v[48:49], v[48:49] op_sel:[0,1]
    v_pk_mov_b32 v[106:107], v[50:51], v[50:51] op_sel:[0,1]
    v_pk_mov_b32 v[108:109], v[52:53], v[52:53] op_sel:[0,1]
    v_pk_mov_b32 v[110:111], v[54:55], v[54:55] op_sel:[0,1]
    v_pk_mov_b32 v[112:113], v[80:81], v[80:81] op_sel:[0,1]
    v_pk_mov_b32 v[114:115], v[82:83], v[82:83] op_sel:[0,1]
    v_pk_mov_b32 v[116:117], v[84:85], v[84:85] op_sel:[0,1]
    v_pk_mov_b32 v[118:119], v[86:87], v[86:87] op_sel:[0,1]
    v_add_u32 v192, 0, v190
    v_add_u32 v193, 55296, v190
    v_add_u32 v194, 79872, v190
    s_branch parallel_sum__sliding_block__dense_activation_gelu__prompt_kernel_redc
parallel_sum__sliding_block__dense_activation_gelu__prompt_kernel_red2:
    s_cmp_lg_u32 s3, 2
    s_cbranch_scc1 parallel_sum__sliding_block__dense_activation_gelu__prompt_kernel_red3
    ds_write_b128 v191, v[0:3] offset:0
    ds_write_b128 v191, v[4:7] offset:1024
    ds_write_b128 v191, v[32:35] offset:2048
    ds_write_b128 v191, v[36:39] offset:3072
    ds_write_b128 v191, v[64:67] offset:4096
    ds_write_b128 v191, v[68:71] offset:5120
    ds_write_b128 v191, v[16:19] offset:6144
    ds_write_b128 v191, v[20:23] offset:7168
    ds_write_b128 v191, v[48:51] offset:8192
    ds_write_b128 v191, v[52:55] offset:9216
    ds_write_b128 v191, v[80:83] offset:10240
    ds_write_b128 v191, v[84:87] offset:11264
    ds_write_b128 v191, v[24:27] offset:12288
    ds_write_b128 v191, v[28:31] offset:13312
    ds_write_b128 v191, v[56:59] offset:14336
    ds_write_b128 v191, v[60:63] offset:15360
    ds_write_b128 v191, v[88:91] offset:16384
    ds_write_b128 v191, v[92:95] offset:17408
    v_pk_mov_b32 v[96:97], v[8:9], v[8:9] op_sel:[0,1]
    v_pk_mov_b32 v[98:99], v[10:11], v[10:11] op_sel:[0,1]
    v_pk_mov_b32 v[100:101], v[12:13], v[12:13] op_sel:[0,1]
    v_pk_mov_b32 v[102:103], v[14:15], v[14:15] op_sel:[0,1]
    v_pk_mov_b32 v[104:105], v[40:41], v[40:41] op_sel:[0,1]
    v_pk_mov_b32 v[106:107], v[42:43], v[42:43] op_sel:[0,1]
    v_pk_mov_b32 v[108:109], v[44:45], v[44:45] op_sel:[0,1]
    v_pk_mov_b32 v[110:111], v[46:47], v[46:47] op_sel:[0,1]
    v_pk_mov_b32 v[112:113], v[72:73], v[72:73] op_sel:[0,1]
    v_pk_mov_b32 v[114:115], v[74:75], v[74:75] op_sel:[0,1]
    v_pk_mov_b32 v[116:117], v[76:77], v[76:77] op_sel:[0,1]
    v_pk_mov_b32 v[118:119], v[78:79], v[78:79] op_sel:[0,1]
    v_add_u32 v192, 6144, v190
    v_add_u32 v193, 30720, v190
    v_add_u32 v194, 86016, v190
    s_branch parallel_sum__sliding_block__dense_activation_gelu__prompt_kernel_redc
parallel_sum__sliding_block__dense_activation_gelu__prompt_kernel_red3:
    ds_write_b128 v191, v[0:3] offset:0
    ds_write_b128 v191, v[4:7] offset:1024
    ds_write_b128 v191, v[32:35] offset:2048
    ds_write_b128 v191, v[36:39] offset:3072
    ds_write_b128 v191, v[64:67] offset:4096
    ds_write_b128 v191, v[68:71] offset:5120
    ds_write_b128 v191, v[16:19] offset:6144
    ds_write_b128 v191, v[20:23] offset:7168
    ds_write_b128 v191, v[48:51] offset:8192
    ds_write_b128 v191, v[52:55] offset:9216
    ds_write_b128 v191, v[80:83] offset:10240
    ds_write_b128 v191, v[84:87] offset:11264
    ds_write_b128 v191, v[8:11] offset:12288
    ds_write_b128 v191, v[12:15] offset:13312
    ds_write_b128 v191, v[40:43] offset:14336
    ds_write_b128 v191, v[44:47] offset:15360
    ds_write_b128 v191, v[72:75] offset:16384
    ds_write_b128 v191, v[76:79] offset:17408
    v_pk_mov_b32 v[96:97], v[24:25], v[24:25] op_sel:[0,1]
    v_pk_mov_b32 v[98:99], v[26:27], v[26:27] op_sel:[0,1]
    v_pk_mov_b32 v[100:101], v[28:29], v[28:29] op_sel:[0,1]
    v_pk_mov_b32 v[102:103], v[30:31], v[30:31] op_sel:[0,1]
    v_pk_mov_b32 v[104:105], v[56:57], v[56:57] op_sel:[0,1]
    v_pk_mov_b32 v[106:107], v[58:59], v[58:59] op_sel:[0,1]
    v_pk_mov_b32 v[108:109], v[60:61], v[60:61] op_sel:[0,1]
    v_pk_mov_b32 v[110:111], v[62:63], v[62:63] op_sel:[0,1]
    v_pk_mov_b32 v[112:113], v[88:89], v[88:89] op_sel:[0,1]
    v_pk_mov_b32 v[114:115], v[90:91], v[90:91] op_sel:[0,1]
    v_pk_mov_b32 v[116:117], v[92:93], v[92:93] op_sel:[0,1]
    v_pk_mov_b32 v[118:119], v[94:95], v[94:95] op_sel:[0,1]
    v_add_u32 v192, 12288, v190
    v_add_u32 v193, 36864, v190
    v_add_u32 v194, 61440, v190
parallel_sum__sliding_block__dense_activation_gelu__prompt_kernel_redc:
    v_lshlrev_b32 v16, 16, v200
    v_and_b32 v17, 0xffff0000, v200
    v_lshlrev_b32 v18, 16, v201
    v_and_b32 v19, 0xffff0000, v201
    v_lshlrev_b32 v20, 16, v202
    v_and_b32 v21, 0xffff0000, v202
    v_lshlrev_b32 v22, 16, v203
    v_and_b32 v23, 0xffff0000, v203
    v_lshlrev_b32 v220, 16, v204
    v_and_b32 v221, 0xffff0000, v204
    v_pk_add_f32 v[220:221], v[220:221], v[16:17]
    v_lshlrev_b32 v222, 16, v205
    v_and_b32 v223, 0xffff0000, v205
    v_pk_add_f32 v[222:223], v[222:223], v[18:19]
    v_lshlrev_b32 v224, 16, v206
    v_and_b32 v225, 0xffff0000, v206
    v_pk_add_f32 v[224:225], v[224:225], v[20:21]
    v_lshlrev_b32 v226, 16, v207
    v_and_b32 v227, 0xffff0000, v207
    v_pk_add_f32 v[226:227], v[226:227], v[22:23]
    v_lshlrev_b32 v228, 16, v208
    v_and_b32 v229, 0xffff0000, v208
    v_pk_add_f32 v[228:229], v[228:229], v[16:17]
    v_lshlrev_b32 v230, 16, v209
    v_and_b32 v231, 0xffff0000, v209
    v_pk_add_f32 v[230:231], v[230:231], v[18:19]
    v_lshlrev_b32 v232, 16, v210
    v_and_b32 v233, 0xffff0000, v210
    v_pk_add_f32 v[232:233], v[232:233], v[20:21]
    v_lshlrev_b32 v234, 16, v211
    v_and_b32 v235, 0xffff0000, v211
    v_pk_add_f32 v[234:235], v[234:235], v[22:23]
    v_lshlrev_b32 v236, 16, v212
    v_and_b32 v237, 0xffff0000, v212
    v_pk_add_f32 v[236:237], v[236:237], v[16:17]
    v_lshlrev_b32 v238, 16, v213
    v_and_b32 v239, 0xffff0000, v213
    v_pk_add_f32 v[238:239], v[238:239], v[18:19]
    v_lshlrev_b32 v240, 16, v214
    v_and_b32 v241, 0xffff0000, v214
    v_pk_add_f32 v[240:241], v[240:241], v[20:21]
    v_lshlrev_b32 v242, 16, v215
    v_and_b32 v243, 0xffff0000, v215
    v_pk_add_f32 v[242:243], v[242:243], v[22:23]
    s_waitcnt lgkmcnt(0)
    s_barrier
    ds_read_b128 v[24:27], v192 offset:0
    ds_read_b128 v[28:31], v192 offset:1024
    ds_read_b128 v[32:35], v192 offset:2048
    ds_read_b128 v[36:39], v192 offset:3072
    ds_read_b128 v[40:43], v192 offset:4096
    ds_read_b128 v[44:47], v192 offset:5120
    ds_read_b128 v[48:51], v193 offset:0
    ds_read_b128 v[52:55], v193 offset:1024
    ds_read_b128 v[56:59], v193 offset:2048
    ds_read_b128 v[60:63], v193 offset:3072
    ds_read_b128 v[64:67], v193 offset:4096
    ds_read_b128 v[68:71], v193 offset:5120
    ds_read_b128 v[72:75], v194 offset:0
    ds_read_b128 v[76:79], v194 offset:1024
    ds_read_b128 v[80:83], v194 offset:2048
    ds_read_b128 v[84:87], v194 offset:3072
    ds_read_b128 v[88:91], v194 offset:4096
    ds_read_b128 v[92:95], v194 offset:5120
    s_waitcnt lgkmcnt(12)
    v_pk_add_f32 v[96:97], v[96:97], v[24:25]
    v_pk_add_f32 v[98:99], v[98:99], v[26:27]
    v_pk_add_f32 v[100:101], v[100:101], v[28:29]
    v_pk_add_f32 v[102:103], v[102:103], v[30:31]
    v_pk_add_f32 v[104:105], v[104:105], v[32:33]
    v_pk_add_f32 v[106:107], v[106:107], v[34:35]
    v_pk_add_f32 v[108:109], v[108:109], v[36:37]
    v_pk_add_f32 v[110:111], v[110:111], v[38:39]
    v_pk_add_f32 v[112:113], v[112:113], v[40:41]
    v_pk_add_f32 v[114:115], v[114:115], v[42:43]
    v_pk_add_f32 v[116:117], v[116:117], v[44:45]
    v_pk_add_f32 v[118:119], v[118:119], v[46:47]
    s_waitcnt lgkmcnt(6)
    v_pk_add_f32 v[96:97], v[96:97], v[48:49]
    v_pk_add_f32 v[98:99], v[98:99], v[50:51]
    v_pk_add_f32 v[100:101], v[100:101], v[52:53]
    v_pk_add_f32 v[102:103], v[102:103], v[54:55]
    v_pk_add_f32 v[104:105], v[104:105], v[56:57]
    v_pk_add_f32 v[106:107], v[106:107], v[58:59]
    v_pk_add_f32 v[108:109], v[108:109], v[60:61]
    v_pk_add_f32 v[110:111], v[110:111], v[62:63]
    v_pk_add_f32 v[112:113], v[112:113], v[64:65]
    v_pk_add_f32 v[114:115], v[114:115], v[66:67]
    v_pk_add_f32 v[116:117], v[116:117], v[68:69]
    v_pk_add_f32 v[118:119], v[118:119], v[70:71]
    s_waitcnt lgkmcnt(0)
    v_pk_add_f32 v[96:97], v[96:97], v[72:73]
    v_pk_add_f32 v[98:99], v[98:99], v[74:75]
    v_pk_add_f32 v[100:101], v[100:101], v[76:77]
    v_pk_add_f32 v[102:103], v[102:103], v[78:79]
    v_pk_add_f32 v[104:105], v[104:105], v[80:81]
    v_pk_add_f32 v[106:107], v[106:107], v[82:83]
    v_pk_add_f32 v[108:109], v[108:109], v[84:85]
    v_pk_add_f32 v[110:111], v[110:111], v[86:87]
    v_pk_add_f32 v[112:113], v[112:113], v[88:89]
    v_pk_add_f32 v[114:115], v[114:115], v[90:91]
    v_pk_add_f32 v[116:117], v[116:117], v[92:93]
    v_pk_add_f32 v[118:119], v[118:119], v[94:95]
    s_nop 1
    v_permlane32_swap_b32 v96, v100
    v_permlane32_swap_b32 v97, v101
    v_permlane32_swap_b32 v98, v102
    v_permlane32_swap_b32 v99, v103
    v_permlane32_swap_b32 v104, v108
    v_permlane32_swap_b32 v105, v109
    v_permlane32_swap_b32 v106, v110
    v_permlane32_swap_b32 v107, v111
    v_permlane32_swap_b32 v112, v116
    v_permlane32_swap_b32 v113, v117
    v_permlane32_swap_b32 v114, v118
    v_permlane32_swap_b32 v115, v119
    s_nop 1
    v_pk_add_f32 v[220:221], v[220:221], v[96:97]
    v_pk_add_f32 v[222:223], v[222:223], v[98:99]
    v_pk_add_f32 v[224:225], v[224:225], v[100:101]
    v_pk_add_f32 v[226:227], v[226:227], v[102:103]
    v_cvt_pk_bf16_f32 v16, v220, v221
    v_cvt_pk_bf16_f32 v17, v222, v223
    v_cvt_pk_bf16_f32 v18, v224, v225
    v_cvt_pk_bf16_f32 v19, v226, v227
    buffer_store_dwordx4 v[16:19], v217, s[28:31], 0 offen
    v_pk_add_f32 v[228:229], v[228:229], v[104:105]
    v_pk_add_f32 v[230:231], v[230:231], v[106:107]
    v_pk_add_f32 v[232:233], v[232:233], v[108:109]
    v_pk_add_f32 v[234:235], v[234:235], v[110:111]
    v_cvt_pk_bf16_f32 v20, v228, v229
    v_cvt_pk_bf16_f32 v21, v230, v231
    v_cvt_pk_bf16_f32 v22, v232, v233
    v_cvt_pk_bf16_f32 v23, v234, v235
    buffer_store_dwordx4 v[20:23], v218, s[28:31], 0 offen
    v_pk_add_f32 v[236:237], v[236:237], v[112:113]
    v_pk_add_f32 v[238:239], v[238:239], v[114:115]
    v_pk_add_f32 v[240:241], v[240:241], v[116:117]
    v_pk_add_f32 v[242:243], v[242:243], v[118:119]
    v_cvt_pk_bf16_f32 v24, v236, v237
    v_cvt_pk_bf16_f32 v25, v238, v239
    v_cvt_pk_bf16_f32 v26, v240, v241
    v_cvt_pk_bf16_f32 v27, v242, v243
    buffer_store_dwordx4 v[24:27], v219, s[28:31], 0 offen
    s_endpgm
parallel_sum__sliding_block__dense_activation_gelu__prompt_kernel_compute:
    s_waitcnt lgkmcnt(0)
    s_mov_b32 s8, s32
    s_and_b32 s9, s33, 0xffff
    s_mov_b32 s10, 2621440
    s_mov_b32 s11, 0x20000
    s_mov_b32 s12, s34
    s_and_b32 s13, s35, 0xffff
    s_mov_b32 s14, 2457600
    s_mov_b32 s15, 0x20000
    s_mov_b32 s16, s36
    s_and_b32 s17, s37, 0xffff
    s_mov_b32 s18, 1966080
    s_mov_b32 s19, 0x20000
    s_mov_b32 s24, s38
    s_and_b32 s25, s39, 0xffff
    s_mov_b32 s26, 3072
    s_mov_b32 s27, 0x20000
    s_mov_b32 s28, s60
    s_and_b32 s29, s61, 0xffff
    s_mov_b32 s30, 256
    s_mov_b32 s31, 0x20000
    s_mov_b32 s20, s62
    s_and_b32 s21, s63, 0xffff
    s_mov_b32 s22, 19922944
    s_mov_b32 s23, 0x20000
    s_mov_b32 s64, s72
    s_and_b32 s65, s73, 0xffff
    s_mov_b32 s66, 819200
    s_mov_b32 s67, 0x20000
    s_mov_b32 s68, s96
    s_and_b32 s69, s97, 0xffff
    s_mov_b32 s70, 1966080
    s_mov_b32 s71, 0x20000
    v_and_b32 v210, 31, v0
    v_lshrrev_b32 v211, 5, v0
    s_cmp_lg_u32 s3, 0
    s_cbranch_scc1 parallel_sum__sliding_block__dense_activation_gelu__prompt_kernel_nononce
    v_mov_b32 v1, 163472
    v_mov_b32 v4, 0
    v_mov_b32 v5, 0
    v_mov_b32 v6, 0
    v_mov_b32 v7, 0
    ds_write_b128 v1, v[4:7]
    ds_write_b128 v1, v[4:7] offset:16
    v_mov_b32 v1, 0
    s_cmp_lg_u32 s2, 0
    s_cbranch_scc1 parallel_sum__sliding_block__dense_activation_gelu__prompt_kernel_nononce
    s_memrealtime s[32:33]
    s_waitcnt lgkmcnt(0)
    s_or_b32 s32, s32, 1
    v_mov_b32 v2, s32
    s_mov_b64 exec, 1
    buffer_store_dword v2, v1, s[28:31], 0 offen sc1
    s_mov_b64 exec, -1
parallel_sum__sliding_block__dense_activation_gelu__prompt_kernel_nononce:
    s_lshl_b32 s6, s3, 5
    v_and_b32 v1, 31, v0
    v_add_u32 v1, s6, v1
    v_bfe_u32 v2, v1, 1, 3
    v_lshrrev_b32 v3, 5, v0
    v_xor_b32 v2, v2, v3
    v_lshlrev_b32 v1, 7, v1
    v_lshl_add_u32 v176, v2, 4, v1
    v_xor_b32 v177, 32, v176
    v_xor_b32 v178, 64, v176
    v_xor_b32 v179, 96, v176
    v_bfe_u32 v1, v0, 2, 2
    v_and_b32 v2, 3, v0
    v_bfe_u32 v3, v0, 4, 1
    v_lshl_add_u32 v2, v3, 2, v2
    v_lshlrev_b32 v2, 3, v2
    v_lshrrev_b32 v3, 5, v0
    v_lshl_add_u32 v3, v3, 3, v1
    v_lshl_add_u32 v4, v3, 8, v2
    v_mul_u32_u24 v24, 192, v3
    v_add_u32 v24, v24, v2
    v_xor_b32 v5, 0, v1
    v_lshl_add_u32 v20, v5, 6, v4
    v_xor_b32 v5, 1, v1
    v_lshl_add_u32 v21, v5, 6, v4
    v_xor_b32 v5, 2, v1
    v_lshl_add_u32 v22, v5, 6, v4
    v_xor_b32 v5, 3, v1
    v_lshl_add_u32 v23, v5, 6, v4
    s_add_u32 s36, s3, 0
    s_add_u32 s37, s3, 1
    s_and_b32 s37, s37, 3
    s_add_u32 s38, s3, 2
    s_and_b32 s38, s38, 3
    s_add_u32 s39, s3, 3
    s_and_b32 s39, s39, 3
    s_cmp_eq_u32 s36, 0
    s_cbranch_scc0 parallel_sum__sliding_block__dense_activation_gelu__prompt_kernel_r00
    v_mov_b32 v180, v20
parallel_sum__sliding_block__dense_activation_gelu__prompt_kernel_r00:
    s_cmp_eq_u32 s36, 1
    s_cbranch_scc0 parallel_sum__sliding_block__dense_activation_gelu__prompt_kernel_r01
    v_mov_b32 v180, v21
parallel_sum__sliding_block__dense_activation_gelu__prompt_kernel_r01:
    s_cmp_eq_u32 s36, 2
    s_cbranch_scc0 parallel_sum__sliding_block__dense_activation_gelu__prompt_kernel_r02
    v_mov_b32 v180, v22
parallel_sum__sliding_block__dense_activation_gelu__prompt_kernel_r02:
    s_cmp_eq_u32 s36, 3
    s_cbranch_scc0 parallel_sum__sliding_block__dense_activation_gelu__prompt_kernel_r03
    v_mov_b32 v180, v23
parallel_sum__sliding_block__dense_activation_gelu__prompt_kernel_r03:
    s_cmp_eq_u32 s37, 0
    s_cbranch_scc0 parallel_sum__sliding_block__dense_activation_gelu__prompt_kernel_r10
    v_mov_b32 v181, v20
parallel_sum__sliding_block__dense_activation_gelu__prompt_kernel_r10:
    s_cmp_eq_u32 s37, 1
    s_cbranch_scc0 parallel_sum__sliding_block__dense_activation_gelu__prompt_kernel_r11
    v_mov_b32 v181, v21
parallel_sum__sliding_block__dense_activation_gelu__prompt_kernel_r11:
    s_cmp_eq_u32 s37, 2
    s_cbranch_scc0 parallel_sum__sliding_block__dense_activation_gelu__prompt_kernel_r12
    v_mov_b32 v181, v22
parallel_sum__sliding_block__dense_activation_gelu__prompt_kernel_r12:
    s_cmp_eq_u32 s37, 3
    s_cbranch_scc0 parallel_sum__sliding_block__dense_activation_gelu__prompt_kernel_r13
    v_mov_b32 v181, v23
parallel_sum__sliding_block__dense_activation_gelu__prompt_kernel_r13:
    s_cmp_eq_u32 s38, 0
    s_cbranch_scc0 parallel_sum__sliding_block__dense_activation_gelu__prompt_kernel_r20
    v_mov_b32 v182, v20
parallel_sum__sliding_block__dense_activation_gelu__prompt_kernel_r20:
    s_cmp_eq_u32 s38, 1
    s_cbranch_scc0 parallel_sum__sliding_block__dense_activation_gelu__prompt_kernel_r21
    v_mov_b32 v182, v21
parallel_sum__sliding_block__dense_activation_gelu__prompt_kernel_r21:
    s_cmp_eq_u32 s38, 2
    s_cbranch_scc0 parallel_sum__sliding_block__dense_activation_gelu__prompt_kernel_r22
    v_mov_b32 v182, v22
parallel_sum__sliding_block__dense_activation_gelu__prompt_kernel_r22:
    s_cmp_eq_u32 s38, 3
    s_cbranch_scc0 parallel_sum__sliding_block__dense_activation_gelu__prompt_kernel_r23
    v_mov_b32 v182, v23
parallel_sum__sliding_block__dense_activation_gelu__prompt_kernel_r23:
    s_cmp_eq_u32 s39, 0
    s_cbranch_scc0 parallel_sum__sliding_block__dense_activation_gelu__prompt_kernel_r30
    v_mov_b32 v183, v20
parallel_sum__sliding_block__dense_activation_gelu__prompt_kernel_r30:
    s_cmp_eq_u32 s39, 1
    s_cbranch_scc0 parallel_sum__sliding_block__dense_activation_gelu__prompt_kernel_r31
    v_mov_b32 v183, v21
parallel_sum__sliding_block__dense_activation_gelu__prompt_kernel_r31:
    s_cmp_eq_u32 s39, 2
    s_cbranch_scc0 parallel_sum__sliding_block__dense_activation_gelu__prompt_kernel_r32
    v_mov_b32 v183, v22
parallel_sum__sliding_block__dense_activation_gelu__prompt_kernel_r32:
    s_cmp_eq_u32 s39, 3
    s_cbranch_scc0 parallel_sum__sliding_block__dense_activation_gelu__prompt_kernel_r33
    v_mov_b32 v183, v23
parallel_sum__sliding_block__dense_activation_gelu__prompt_kernel_r33:
    s_cmp_eq_u32 s3, 3
    s_cselect_b32 s58, 0, s3
    s_add_u32 s59, s58, 1
    s_cmp_eq_u32 s59, 3
    s_cselect_b32 s59, 0, s59
    s_add_u32 s60, s59, 1
    s_cmp_eq_u32 s60, 3
    s_cselect_b32 s60, 0, s60
    s_lshl_b32 s6, s58, 6
    v_add_u32 v184, s6, v24
    s_lshl_b32 s6, s59, 6
    v_add_u32 v185, s6, v24
    s_lshl_b32 s6, s60, 6
    v_add_u32 v186, s6, v24
    v_add_u32 v176, 32768, v176
    v_add_u32 v177, 32768, v177
    v_add_u32 v178, 32768, v178
    v_add_u32 v179, 32768, v179
    v_add_u32 v180, 32768, v180
    v_add_u32 v181, 32768, v181
    v_add_u32 v182, 32768, v182
    v_add_u32 v183, 32768, v183
    v_add_u32 v184, 98304, v184
    v_add_u32 v185, 98304, v185
    v_add_u32 v186, 98304, v186
    v_and_b32 v1, 15, v0
    v_bfe_u32 v2, v0, 4, 1
    v_cmp_eq_u32 vcc, v1, v2
    v_mov_b32 v1, 0x3f803f80
    v_cndmask_b32 v96, 0, v1, vcc
    v_mov_b32 v97, v96
    v_mov_b32 v98, v96
    v_mov_b32 v99, v96
    v_mov_b32 v0, 0
    v_mov_b32 v1, 0
    v_mov_b32 v2, 0
    v_mov_b32 v3, 0
    v_mov_b32 v4, 0
    v_mov_b32 v5, 0
    v_mov_b32 v6, 0
    v_mov_b32 v7, 0
    v_mov_b32 v8, 0
    v_mov_b32 v9, 0
    v_mov_b32 v10, 0
    v_mov_b32 v11, 0
    v_mov_b32 v12, 0
    v_mov_b32 v13, 0
    v_mov_b32 v14, 0
    v_mov_b32 v15, 0
    v_mov_b32 v16, 0
    v_mov_b32 v17, 0
    v_mov_b32 v18, 0
    v_mov_b32 v19, 0
    v_mov_b32 v20, 0
    v_mov_b32 v21, 0
    v_mov_b32 v22, 0
    v_mov_b32 v23, 0
    v_mov_b32 v24, 0
    v_mov_b32 v25, 0
    v_mov_b32 v26, 0
    v_mov_b32 v27, 0
    v_mov_b32 v28, 0
    v_mov_b32 v29, 0
    v_mov_b32 v30, 0
    v_mov_b32 v31, 0
    v_mov_b32 v32, 0
    v_mov_b32 v33, 0
    v_mov_b32 v34, 0
    v_mov_b32 v35, 0
    v_mov_b32 v36, 0
    v_mov_b32 v37, 0
    v_mov_b32 v38, 0
    v_mov_b32 v39, 0
    v_mov_b32 v40, 0
    v_mov_b32 v41, 0
    v_mov_b32 v42, 0
    v_mov_b32 v43, 0
    v_mov_b32 v44, 0
    v_mov_b32 v45, 0
    v_mov_b32 v46, 0
    v_mov_b32 v47, 0
    v_mov_b32 v48, 0
    v_mov_b32 v49, 0
    v_mov_b32 v50, 0
    v_mov_b32 v51, 0
    v_mov_b32 v52, 0
    v_mov_b32 v53, 0
    v_mov_b32 v54, 0
    v_mov_b32 v55, 0
    v_mov_b32 v56, 0
    v_mov_b32 v57, 0
    v_mov_b32 v58, 0
    v_mov_b32 v59, 0
    v_mov_b32 v60, 0
    v_mov_b32 v61, 0
    v_mov_b32 v62, 0
    v_mov_b32 v63, 0
    v_mov_b32 v100, 0
    v_mov_b32 v101, 0
    v_mov_b32 v102, 0
    v_mov_b32 v103, 0
    s_mov_b32 s50, 1
    s_waitcnt lgkmcnt(0)
    s_barrier
    ds_read_b128 v[64:67], v176
    ds_read_b64_tr_b16 v[68:69], v180 offset:16384
    ds_read_b64_tr_b16 v[70:71], v180 offset:17408
    ds_read_b64_tr_b16 v[72:73], v181 offset:16384
    ds_read_b64_tr_b16 v[74:75], v181 offset:17408
    ds_read_b64_tr_b16 v[76:77], v182 offset:16384
    ds_read_b64_tr_b16 v[78:79], v182 offset:17408
    ds_read_b64_tr_b16 v[80:81], v183 offset:16384
    ds_read_b64_tr_b16 v[82:83], v183 offset:17408
    ds_read_b128 v[104:107], v177
    ds_read_b64_tr_b16 v[108:109], v180 offset:20480
    ds_read_b64_tr_b16 v[110:111], v180 offset:21504
    ds_read_b64_tr_b16 v[112:113], v181 offset:20480
    ds_read_b64_tr_b16 v[114:115], v181 offset:21504
    ds_read_b64_tr_b16 v[116:117], v182 offset:20480
    ds_read_b64_tr_b16 v[118:119], v182 offset:21504
    ds_read_b64_tr_b16 v[120:121], v183 offset:20480
    ds_read_b64_tr_b16 v[122:123], v183 offset:21504
    s_mov_b32 s46, 0
parallel_sum__sliding_block__dense_activation_gelu__prompt_kernel_p1:
    s_waitcnt lgkmcnt(9)
    v_mfma_f32_32x32x16_bf16 v[0:15], v[68:71], v[64:67], v[0:15]
    ds_read_b128 v[124:127], v178
    ds_read_b64_tr_b16 v[128:129], v180 offset:24576
    ds_read_b64_tr_b16 v[130:131], v180 offset:25600
    v_mfma_f32_16x16x32_bf16 v[100:103], v[68:71], v[96:99], v[100:103]
    ds_read_b64_tr_b16 v[132:133], v181 offset:24576
    ds_read_b64_tr_b16 v[134:135], v181 offset:25600
    v_mfma_f32_32x32x16_bf16 v[16:31], v[72:75], v[64:67], v[16:31]
    ds_read_b64_tr_b16 v[136:137], v182 offset:24576
    ds_read_b64_tr_b16 v[138:139], v182 offset:25600
    ds_read_b64_tr_b16 v[140:141], v183 offset:24576
    v_mfma_f32_32x32x16_bf16 v[32:47], v[76:79], v[64:67], v[32:47]
    ds_read_b64_tr_b16 v[142:143], v183 offset:25600
    v_mfma_f32_32x32x16_bf16 v[48:63], v[80:83], v[64:67], v[48:63]
    s_waitcnt lgkmcnt(9)
    v_mfma_f32_32x32x16_bf16 v[0:15], v[108:111], v[104:107], v[0:15]
    ds_read_b128 v[144:147], v179
    ds_read_b64_tr_b16 v[148:149], v180 offset:28672
    ds_read_b64_tr_b16 v[150:151], v180 offset:29696
    v_mfma_f32_16x16x32_bf16 v[100:103], v[108:111], v[96:99], v[100:103]
    ds_read_b64_tr_b16 v[152:153], v181 offset:28672
    ds_read_b64_tr_b16 v[154:155], v181 offset:29696
    v_mfma_f32_32x32x16_bf16 v[16:31], v[112:115], v[104:107], v[16:31]
    ds_read_b64_tr_b16 v[156:157], v182 offset:28672
    ds_read_b64_tr_b16 v[158:159], v182 offset:29696
    ds_read_b64_tr_b16 v[160:161], v183 offset:28672
    v_mfma_f32_32x32x16_bf16 v[32:47], v[116:119], v[104:107], v[32:47]
    ds_read_b64_tr_b16 v[162:163], v183 offset:29696
    v_mfma_f32_32x32x16_bf16 v[48:63], v[120:123], v[104:107], v[48:63]
    s_waitcnt lgkmcnt(9)
    v_mfma_f32_32x32x16_bf16 v[0:15], v[128:131], v[124:127], v[0:15]
    s_add_u32 s50, s50, 1
    s_cmp_eq_u32 s50, 4
    s_cselect_b32 s47, s51, 32768
    s_cselect_b32 s50, 0, s50
    v_mfma_f32_16x16x32_bf16 v[100:103], v[128:131], v[96:99], v[100:103]
    v_add_u32 v176, s47, v176
    v_add_u32 v177, s47, v177
    v_add_u32 v178, s47, v178
    v_add_u32 v179, s47, v179
    v_mfma_f32_32x32x16_bf16 v[16:31], v[132:135], v[124:127], v[16:31]
    v_add_u32 v180, s47, v180
    v_add_u32 v181, s47, v181
    v_add_u32 v182, s47, v182
    v_add_u32 v183, s47, v183
    v_mfma_f32_32x32x16_bf16 v[32:47], v[136:139], v[124:127], v[32:47]
    s_waitcnt lgkmcnt(0)
    s_barrier
    ds_read_b128 v[64:67], v176
    ds_read_b64_tr_b16 v[68:69], v180 offset:16384
    ds_read_b64_tr_b16 v[70:71], v180 offset:17408
    ds_read_b64_tr_b16 v[72:73], v181 offset:16384
    ds_read_b64_tr_b16 v[74:75], v181 offset:17408
    v_mfma_f32_32x32x16_bf16 v[48:63], v[140:143], v[124:127], v[48:63]
    ds_read_b64_tr_b16 v[76:77], v182 offset:16384
    ds_read_b64_tr_b16 v[78:79], v182 offset:17408
    ds_read_b64_tr_b16 v[80:81], v183 offset:16384
    ds_read_b64_tr_b16 v[82:83], v183 offset:17408
    v_mfma_f32_32x32x16_bf16 v[0:15], v[148:151], v[144:147], v[0:15]
    ds_read_b128 v[104:107], v177
    ds_read_b64_tr_b16 v[108:109], v180 offset:20480
    ds_read_b64_tr_b16 v[110:111], v180 offset:21504
    v_mfma_f32_16x16x32_bf16 v[100:103], v[148:151], v[96:99], v[100:103]
    ds_read_b64_tr_b16 v[112:113], v181 offset:20480
    ds_read_b64_tr_b16 v[114:115], v181 offset:21504
    v_mfma_f32_32x32x16_bf16 v[16:31], v[152:155], v[144:147], v[16:31]
    ds_read_b64_tr_b16 v[116:117], v182 offset:20480
    ds_read_b64_tr_b16 v[118:119], v182 offset:21504
    ds_read_b64_tr_b16 v[120:121], v183 offset:20480
    v_mfma_f32_32x32x16_bf16 v[32:47], v[156:159], v[144:147], v[32:47]
    ds_read_b64_tr_b16 v[122:123], v183 offset:21504
    v_mfma_f32_32x32x16_bf16 v[48:63], v[160:163], v[144:147], v[48:63]
    s_add_u32 s46, s46, 1
    s_cmp_lt_u32 s46, 9
    s_cbranch_scc1 parallel_sum__sliding_block__dense_activation_gelu__prompt_kernel_p1
    s_waitcnt lgkmcnt(9)
    v_mfma_f32_32x32x16_bf16 v[0:15], v[68:71], v[64:67], v[0:15]
    ds_read_b128 v[124:127], v178
    ds_read_b64_tr_b16 v[128:129], v180 offset:24576
    ds_read_b64_tr_b16 v[130:131], v180 offset:25600
    v_mfma_f32_16x16x32_bf16 v[100:103], v[68:71], v[96:99], v[100:103]
    ds_read_b64_tr_b16 v[132:133], v181 offset:24576
    ds_read_b64_tr_b16 v[134:135], v181 offset:25600
    v_mfma_f32_32x32x16_bf16 v[16:31], v[72:75], v[64:67], v[16:31]
    ds_read_b64_tr_b16 v[136:137], v182 offset:24576
    ds_read_b64_tr_b16 v[138:139], v182 offset:25600
    ds_read_b64_tr_b16 v[140:141], v183 offset:24576
    v_mfma_f32_32x32x16_bf16 v[32:47], v[76:79], v[64:67], v[32:47]
    ds_read_b64_tr_b16 v[142:143], v183 offset:25600
    v_mfma_f32_32x32x16_bf16 v[48:63], v[80:83], v[64:67], v[48:63]
    s_waitcnt lgkmcnt(9)
    v_mfma_f32_32x32x16_bf16 v[0:15], v[108:111], v[104:107], v[0:15]
    ds_read_b128 v[144:147], v179
    ds_read_b64_tr_b16 v[148:149], v180 offset:28672
    ds_read_b64_tr_b16 v[150:151], v180 offset:29696
    v_mfma_f32_16x16x32_bf16 v[100:103], v[108:111], v[96:99], v[100:103]
    ds_read_b64_tr_b16 v[152:153], v181 offset:28672
    ds_read_b64_tr_b16 v[154:155], v181 offset:29696
    v_mfma_f32_32x32x16_bf16 v[16:31], v[112:115], v[104:107], v[16:31]
    ds_read_b64_tr_b16 v[156:157], v182 offset:28672
    ds_read_b64_tr_b16 v[158:159], v182 offset:29696
    ds_read_b64_tr_b16 v[160:161], v183 offset:28672
    v_mfma_f32_32x32x16_bf16 v[32:47], v[116:119], v[104:107], v[32:47]
    ds_read_b64_tr_b16 v[162:163], v183 offset:29696
    v_mfma_f32_32x32x16_bf16 v[48:63], v[120:123], v[104:107], v[48:63]
    s_waitcnt lgkmcnt(9)
    v_mfma_f32_32x32x16_bf16 v[0:15], v[128:131], v[124:127], v[0:15]
    v_mfma_f32_16x16x32_bf16 v[100:103], v[128:131], v[96:99], v[100:103]
    v_mfma_f32_32x32x16_bf16 v[16:31], v[132:135], v[124:127], v[16:31]
    v_mfma_f32_32x32x16_bf16 v[32:47], v[136:139], v[124:127], v[32:47]
    v_mfma_f32_32x32x16_bf16 v[48:63], v[140:143], v[124:127], v[48:63]
    s_waitcnt lgkmcnt(0)
    v_mfma_f32_32x32x16_bf16 v[0:15], v[148:151], v[144:147], v[0:15]
    v_mfma_f32_16x16x32_bf16 v[100:103], v[148:151], v[96:99], v[100:103]
    v_mfma_f32_32x32x16_bf16 v[16:31], v[152:155], v[144:147], v[16:31]
    v_mfma_f32_32x32x16_bf16 v[32:47], v[156:159], v[144:147], v[32:47]
    v_mfma_f32_32x32x16_bf16 v[48:63], v[160:163], v[144:147], v[48:63]
    s_add_u32 s50, s50, 1
    s_cmp_eq_u32 s50, 4
    s_cselect_b32 s47, s51, 32768
    s_cselect_b32 s50, 0, s50
    v_add_u32 v176, s47, v176
    v_add_u32 v177, s47, v177
    v_add_u32 v178, s47, v178
    v_add_u32 v179, s47, v179
    v_add_u32 v180, s47, v180
    v_add_u32 v181, s47, v181
    v_add_u32 v182, s47, v182
    v_add_u32 v183, s47, v183
    v_lshl_add_u32 v196, v211, 5, v210
    v_and_b32 v197, 1, v196
    v_lshrrev_b32 v196, 4, v196
    v_lshlrev_b32 v196, 4, v196
    v_lshl_add_u32 v196, v197, 6, v196
    s_lshl_b32 s6, s36, 7
    s_add_u32 s6, s6, 161152
    v_add_u32 v196, s6, v196
    s_nop 7
    s_mov_b32 s32, 0x00030003
    s_mov_b32 s33, 0x00030003
    s_mov_b64 exec, s[32:33]
    ds_write_b128 v196, v[100:103]
    s_mov_b64 exec, -1
    s_waitcnt lgkmcnt(0)
    s_barrier
    s_lshl_b32 s6, s3, 5
    v_add_u32 v195, s6, v210
    v_lshlrev_b32 v196, 3, v195
    v_add_u32 v196, 162432, v196
    ds_read_b64 v[190:191], v196
    v_mov_b32 v197, 163456
    ds_read_b32 v197, v197
    v_lshlrev_b32 v194, 4, v211
    v_add_u32 v194, 161152, v194
    s_lshl_b32 s95, s4, 4
    s_add_u32 s95, s95, s5
    s_lshl_b32 s95, s95, 7
    s_add_u32 s95, s95, 18415616
    s_lshl_b32 s6, s36, 7
    v_add_u32 v198, s6, v194
    s_lshl_b32 s6, s37, 7
    v_add_u32 v199, s6, v194
    s_lshl_b32 s6, s38, 7
    v_add_u32 v200, s6, v194
    s_lshl_b32 s6, s39, 7
    v_add_u32 v201, s6, v194
    ds_read_b128 v[112:115], v198 offset:0
    ds_read_b128 v[116:119], v198 offset:32
    ds_read_b128 v[120:123], v198 offset:64
    ds_read_b128 v[124:127], v198 offset:96
    ds_read_b128 v[128:131], v199 offset:0
    ds_read_b128 v[132:135], v199 offset:32
    ds_read_b128 v[136:139], v199 offset:64
    ds_read_b128 v[140:143], v199 offset:96
    ds_read_b128 v[144:147], v200 offset:0
    ds_read_b128 v[148:151], v200 offset:32
    ds_read_b128 v[152:155], v200 offset:64
    ds_read_b128 v[156:159], v200 offset:96
    ds_read_b128 v[160:163], v201 offset:0
    ds_read_b128 v[164:167], v201 offset:32
    ds_read_b128 v[168:171], v201 offset:64
    ds_read_b128 v[172:175], v201 offset:96
    s_cmp_lt_u32 s5, 5
    s_cselect_b32 s56, 0x3ea52b5c, 1.0
    v_lshlrev_b32 v195, 4, v195
    v_lshl_add_u32 v195, v211, 11, v195
    s_cmp_eq_u32 s5, 15
    s_cselect_b32 s7, 0x7f000000, 0
    v_or_b32 v195, s7, v195
    s_mul_i32 s35, s4, 240
    s_lshl_b32 s7, s5, 4
    s_add_u32 s35, s35, s7
    s_lshl_b32 s35, s35, 11
    s_add_u32 s35, s35, 9437184
    s_waitcnt lgkmcnt(15)
    v_readfirstlane_b32 s94, v197
    v_mul_f32 v192, s56, v190
    v_mul_f32 v193, s56, v191
    s_waitcnt lgkmcnt(12)
    v_pk_mul_f32 v[112:113], v[112:113], v[192:193] op_sel:[0,1] op_sel_hi:[1,1]
    v_pk_mul_f32 v[114:115], v[114:115], v[192:193] op_sel:[0,1] op_sel_hi:[1,1]
    v_pk_fma_f32 v[0:1], v[0:1], v[192:193], v[112:113] op_sel:[0,0,0] op_sel_hi:[1,0,1]
    v_pk_fma_f32 v[2:3], v[2:3], v[192:193], v[114:115] op_sel:[0,0,0] op_sel_hi:[1,0,1]
    v_pk_mul_f32 v[116:117], v[116:117], v[192:193] op_sel:[0,1] op_sel_hi:[1,1]
    v_pk_mul_f32 v[118:119], v[118:119], v[192:193] op_sel:[0,1] op_sel_hi:[1,1]
    v_pk_fma_f32 v[4:5], v[4:5], v[192:193], v[116:117] op_sel:[0,0,0] op_sel_hi:[1,0,1]
    v_pk_fma_f32 v[6:7], v[6:7], v[192:193], v[118:119] op_sel:[0,0,0] op_sel_hi:[1,0,1]
    v_pk_mul_f32 v[120:121], v[120:121], v[192:193] op_sel:[0,1] op_sel_hi:[1,1]
    v_pk_mul_f32 v[122:123], v[122:123], v[192:193] op_sel:[0,1] op_sel_hi:[1,1]
    v_pk_fma_f32 v[8:9], v[8:9], v[192:193], v[120:121] op_sel:[0,0,0] op_sel_hi:[1,0,1]
    v_pk_fma_f32 v[10:11], v[10:11], v[192:193], v[122:123] op_sel:[0,0,0] op_sel_hi:[1,0,1]
    v_pk_mul_f32 v[124:125], v[124:125], v[192:193] op_sel:[0,1] op_sel_hi:[1,1]
    v_pk_mul_f32 v[126:127], v[126:127], v[192:193] op_sel:[0,1] op_sel_hi:[1,1]
    v_pk_fma_f32 v[12:13], v[12:13], v[192:193], v[124:125] op_sel:[0,0,0] op_sel_hi:[1,0,1]
    v_pk_fma_f32 v[14:15], v[14:15], v[192:193], v[126:127] op_sel:[0,0,0] op_sel_hi:[1,0,1]
    v_cvt_pk_bf16_f32 v112, v0, v1
    v_cvt_pk_bf16_f32 v113, v2, v3
    v_cvt_pk_bf16_f32 v114, v4, v5
    v_cvt_pk_bf16_f32 v115, v6, v7
    v_cvt_pk_bf16_f32 v116, v8, v9
    v_cvt_pk_bf16_f32 v117, v10, v11
    v_cvt_pk_bf16_f32 v118, v12, v13
    v_cvt_pk_bf16_f32 v119, v14, v15
    s_lshl_b32 s6, s36, 13
    s_add_u32 s6, s6, s35
    v_permlane32_swap_b32 v112, v114
    v_permlane32_swap_b32 v113, v115
    v_permlane32_swap_b32 v116, v118
    v_permlane32_swap_b32 v117, v119
    buffer_store_dwordx4 v[112:115], v195, s[20:23], s6 offen sc1
    s_add_u32 s6, s6, 4096
    buffer_store_dwordx4 v[116:119], v195, s[20:23], s6 offen sc1
    s_waitcnt lgkmcnt(8)
    v_pk_mul_f32 v[128:129], v[128:129], v[192:193] op_sel:[0,1] op_sel_hi:[1,1]
    v_pk_mul_f32 v[130:131], v[130:131], v[192:193] op_sel:[0,1] op_sel_hi:[1,1]
    v_pk_fma_f32 v[16:17], v[16:17], v[192:193], v[128:129] op_sel:[0,0,0] op_sel_hi:[1,0,1]
    v_pk_fma_f32 v[18:19], v[18:19], v[192:193], v[130:131] op_sel:[0,0,0] op_sel_hi:[1,0,1]
    v_pk_mul_f32 v[132:133], v[132:133], v[192:193] op_sel:[0,1] op_sel_hi:[1,1]
    v_pk_mul_f32 v[134:135], v[134:135], v[192:193] op_sel:[0,1] op_sel_hi:[1,1]
    v_pk_fma_f32 v[20:21], v[20:21], v[192:193], v[132:133] op_sel:[0,0,0] op_sel_hi:[1,0,1]
    v_pk_fma_f32 v[22:23], v[22:23], v[192:193], v[134:135] op_sel:[0,0,0] op_sel_hi:[1,0,1]
    v_pk_mul_f32 v[136:137], v[136:137], v[192:193] op_sel:[0,1] op_sel_hi:[1,1]
    v_pk_mul_f32 v[138:139], v[138:139], v[192:193] op_sel:[0,1] op_sel_hi:[1,1]
    v_pk_fma_f32 v[24:25], v[24:25], v[192:193], v[136:137] op_sel:[0,0,0] op_sel_hi:[1,0,1]
    v_pk_fma_f32 v[26:27], v[26:27], v[192:193], v[138:139] op_sel:[0,0,0] op_sel_hi:[1,0,1]
    v_pk_mul_f32 v[140:141], v[140:141], v[192:193] op_sel:[0,1] op_sel_hi:[1,1]
    v_pk_mul_f32 v[142:143], v[142:143], v[192:193] op_sel:[0,1] op_sel_hi:[1,1]
    v_pk_fma_f32 v[28:29], v[28:29], v[192:193], v[140:141] op_sel:[0,0,0] op_sel_hi:[1,0,1]
    v_pk_fma_f32 v[30:31], v[30:31], v[192:193], v[142:143] op_sel:[0,0,0] op_sel_hi:[1,0,1]
    v_cvt_pk_bf16_f32 v128, v16, v17
    v_cvt_pk_bf16_f32 v129, v18, v19
    v_cvt_pk_bf16_f32 v130, v20, v21
    v_cvt_pk_bf16_f32 v131, v22, v23
    v_cvt_pk_bf16_f32 v132, v24, v25
    v_cvt_pk_bf16_f32 v133, v26, v27
    v_cvt_pk_bf16_f32 v134, v28, v29
    v_cvt_pk_bf16_f32 v135, v30, v31
    s_lshl_b32 s6, s37, 13
    s_add_u32 s6, s6, s35
    v_permlane32_swap_b32 v128, v130
    v_permlane32_swap_b32 v129, v131
    v_permlane32_swap_b32 v132, v134
    v_permlane32_swap_b32 v133, v135
    buffer_store_dwordx4 v[128:131], v195, s[20:23], s6 offen sc1
    s_add_u32 s6, s6, 4096
    buffer_store_dwordx4 v[132:135], v195, s[20:23], s6 offen sc1
    s_waitcnt lgkmcnt(4)
    v_pk_mul_f32 v[144:145], v[144:145], v[192:193] op_sel:[0,1] op_sel_hi:[1,1]
    v_pk_mul_f32 v[146:147], v[146:147], v[192:193] op_sel:[0,1] op_sel_hi:[1,1]
    v_pk_fma_f32 v[32:33], v[32:33], v[192:193], v[144:145] op_sel:[0,0,0] op_sel_hi:[1,0,1]
    v_pk_fma_f32 v[34:35], v[34:35], v[192:193], v[146:147] op_sel:[0,0,0] op_sel_hi:[1,0,1]
    v_pk_mul_f32 v[148:149], v[148:149], v[192:193] op_sel:[0,1] op_sel_hi:[1,1]
    v_pk_mul_f32 v[150:151], v[150:151], v[192:193] op_sel:[0,1] op_sel_hi:[1,1]
    v_pk_fma_f32 v[36:37], v[36:37], v[192:193], v[148:149] op_sel:[0,0,0] op_sel_hi:[1,0,1]
    v_pk_fma_f32 v[38:39], v[38:39], v[192:193], v[150:151] op_sel:[0,0,0] op_sel_hi:[1,0,1]
    v_pk_mul_f32 v[152:153], v[152:153], v[192:193] op_sel:[0,1] op_sel_hi:[1,1]
    v_pk_mul_f32 v[154:155], v[154:155], v[192:193] op_sel:[0,1] op_sel_hi:[1,1]
    v_pk_fma_f32 v[40:41], v[40:41], v[192:193], v[152:153] op_sel:[0,0,0] op_sel_hi:[1,0,1]
    v_pk_fma_f32 v[42:43], v[42:43], v[192:193], v[154:155] op_sel:[0,0,0] op_sel_hi:[1,0,1]
    v_pk_mul_f32 v[156:157], v[156:157], v[192:193] op_sel:[0,1] op_sel_hi:[1,1]
    v_pk_mul_f32 v[158:159], v[158:159], v[192:193] op_sel:[0,1] op_sel_hi:[1,1]
    v_pk_fma_f32 v[44:45], v[44:45], v[192:193], v[156:157] op_sel:[0,0,0] op_sel_hi:[1,0,1]
    v_pk_fma_f32 v[46:47], v[46:47], v[192:193], v[158:159] op_sel:[0,0,0] op_sel_hi:[1,0,1]
    v_cvt_pk_bf16_f32 v144, v32, v33
    v_cvt_pk_bf16_f32 v145, v34, v35
    v_cvt_pk_bf16_f32 v146, v36, v37
    v_cvt_pk_bf16_f32 v147, v38, v39
    v_cvt_pk_bf16_f32 v148, v40, v41
    v_cvt_pk_bf16_f32 v149, v42, v43
    v_cvt_pk_bf16_f32 v150, v44, v45
    v_cvt_pk_bf16_f32 v151, v46, v47
    s_lshl_b32 s6, s38, 13
    s_add_u32 s6, s6, s35
    v_permlane32_swap_b32 v144, v146
    v_permlane32_swap_b32 v145, v147
    v_permlane32_swap_b32 v148, v150
    v_permlane32_swap_b32 v149, v151
    buffer_store_dwordx4 v[144:147], v195, s[20:23], s6 offen sc1
    s_add_u32 s6, s6, 4096
    buffer_store_dwordx4 v[148:151], v195, s[20:23], s6 offen sc1
    s_waitcnt lgkmcnt(0)
    v_pk_mul_f32 v[160:161], v[160:161], v[192:193] op_sel:[0,1] op_sel_hi:[1,1]
    v_pk_mul_f32 v[162:163], v[162:163], v[192:193] op_sel:[0,1] op_sel_hi:[1,1]
    v_pk_fma_f32 v[48:49], v[48:49], v[192:193], v[160:161] op_sel:[0,0,0] op_sel_hi:[1,0,1]
    v_pk_fma_f32 v[50:51], v[50:51], v[192:193], v[162:163] op_sel:[0,0,0] op_sel_hi:[1,0,1]
    v_pk_mul_f32 v[164:165], v[164:165], v[192:193] op_sel:[0,1] op_sel_hi:[1,1]
    v_pk_mul_f32 v[166:167], v[166:167], v[192:193] op_sel:[0,1] op_sel_hi:[1,1]
    v_pk_fma_f32 v[52:53], v[52:53], v[192:193], v[164:165] op_sel:[0,0,0] op_sel_hi:[1,0,1]
    v_pk_fma_f32 v[54:55], v[54:55], v[192:193], v[166:167] op_sel:[0,0,0] op_sel_hi:[1,0,1]
    v_pk_mul_f32 v[168:169], v[168:169], v[192:193] op_sel:[0,1] op_sel_hi:[1,1]
    v_pk_mul_f32 v[170:171], v[170:171], v[192:193] op_sel:[0,1] op_sel_hi:[1,1]
    v_pk_fma_f32 v[56:57], v[56:57], v[192:193], v[168:169] op_sel:[0,0,0] op_sel_hi:[1,0,1]
    v_pk_fma_f32 v[58:59], v[58:59], v[192:193], v[170:171] op_sel:[0,0,0] op_sel_hi:[1,0,1]
    v_pk_mul_f32 v[172:173], v[172:173], v[192:193] op_sel:[0,1] op_sel_hi:[1,1]
    v_pk_mul_f32 v[174:175], v[174:175], v[192:193] op_sel:[0,1] op_sel_hi:[1,1]
    v_pk_fma_f32 v[60:61], v[60:61], v[192:193], v[172:173] op_sel:[0,0,0] op_sel_hi:[1,0,1]
    v_pk_fma_f32 v[62:63], v[62:63], v[192:193], v[174:175] op_sel:[0,0,0] op_sel_hi:[1,0,1]
    v_cvt_pk_bf16_f32 v160, v48, v49
    v_cvt_pk_bf16_f32 v161, v50, v51
    v_cvt_pk_bf16_f32 v162, v52, v53
    v_cvt_pk_bf16_f32 v163, v54, v55
    v_cvt_pk_bf16_f32 v164, v56, v57
    v_cvt_pk_bf16_f32 v165, v58, v59
    v_cvt_pk_bf16_f32 v166, v60, v61
    v_cvt_pk_bf16_f32 v167, v62, v63
    s_lshl_b32 s6, s39, 13
    s_add_u32 s6, s6, s35
    v_permlane32_swap_b32 v160, v162
    v_permlane32_swap_b32 v161, v163
    v_permlane32_swap_b32 v164, v166
    v_permlane32_swap_b32 v165, v167
    buffer_store_dwordx4 v[160:163], v195, s[20:23], s6 offen sc1
    s_add_u32 s6, s6, 4096
    buffer_store_dwordx4 v[164:167], v195, s[20:23], s6 offen sc1
    v_mov_b32 v0, 0
    v_mov_b32 v1, 0
    v_mov_b32 v2, 0
    v_mov_b32 v3, 0
    v_mov_b32 v4, 0
    v_mov_b32 v5, 0
    v_mov_b32 v6, 0
    v_mov_b32 v7, 0
    v_mov_b32 v8, 0
    v_mov_b32 v9, 0
    v_mov_b32 v10, 0
    v_mov_b32 v11, 0
    v_mov_b32 v12, 0
    v_mov_b32 v13, 0
    v_mov_b32 v14, 0
    v_mov_b32 v15, 0
    v_mov_b32 v16, 0
    v_mov_b32 v17, 0
    v_mov_b32 v18, 0
    v_mov_b32 v19, 0
    v_mov_b32 v20, 0
    v_mov_b32 v21, 0
    v_mov_b32 v22, 0
    v_mov_b32 v23, 0
    v_mov_b32 v24, 0
    v_mov_b32 v25, 0
    v_mov_b32 v26, 0
    v_mov_b32 v27, 0
    v_mov_b32 v28, 0
    v_mov_b32 v29, 0
    v_mov_b32 v30, 0
    v_mov_b32 v31, 0
    v_mov_b32 v32, 0
    v_mov_b32 v33, 0
    v_mov_b32 v34, 0
    v_mov_b32 v35, 0
    v_mov_b32 v36, 0
    v_mov_b32 v37, 0
    v_mov_b32 v38, 0
    v_mov_b32 v39, 0
    v_mov_b32 v40, 0
    v_mov_b32 v41, 0
    v_mov_b32 v42, 0
    v_mov_b32 v43, 0
    v_mov_b32 v44, 0
    v_mov_b32 v45, 0
    v_mov_b32 v46, 0
    v_mov_b32 v47, 0
    v_mov_b32 v100, 0
    v_mov_b32 v101, 0
    v_mov_b32 v102, 0
    v_mov_b32 v103, 0
    s_barrier
    ds_read_b128 v[64:67], v176
    ds_read_b64_tr_b16 v[68:69], v184 offset:16384
    ds_read_b64_tr_b16 v[70:71], v184 offset:17152
    ds_read_b64_tr_b16 v[72:73], v185 offset:16384
    ds_read_b64_tr_b16 v[74:75], v185 offset:17152
    ds_read_b64_tr_b16 v[76:77], v186 offset:16384
    ds_read_b64_tr_b16 v[78:79], v186 offset:17152
    ds_read_b128 v[104:107], v177
    ds_read_b64_tr_b16 v[108:109], v184 offset:19456
    ds_read_b64_tr_b16 v[110:111], v184 offset:20224
    ds_read_b64_tr_b16 v[112:113], v185 offset:19456
    ds_read_b64_tr_b16 v[114:115], v185 offset:20224
    ds_read_b64_tr_b16 v[116:117], v186 offset:19456
    ds_read_b64_tr_b16 v[118:119], v186 offset:20224
    s_mov_b32 s46, 0
parallel_sum__sliding_block__dense_activation_gelu__prompt_kernel_p2:
    s_waitcnt lgkmcnt(7)
    v_mfma_f32_32x32x16_bf16 v[0:15], v[68:71], v[64:67], v[0:15]
    ds_read_b128 v[124:127], v178
    ds_read_b64_tr_b16 v[128:129], v184 offset:22528
    ds_read_b64_tr_b16 v[130:131], v184 offset:23296
    v_mfma_f32_16x16x32_bf16 v[100:103], v[68:71], v[96:99], v[100:103]
    ds_read_b64_tr_b16 v[132:133], v185 offset:22528
    ds_read_b64_tr_b16 v[134:135], v185 offset:23296
    v_mfma_f32_32x32x16_bf16 v[16:31], v[72:75], v[64:67], v[16:31]
    ds_read_b64_tr_b16 v[136:137], v186 offset:22528
    ds_read_b64_tr_b16 v[138:139], v186 offset:23296
    v_mfma_f32_32x32x16_bf16 v[32:47], v[76:79], v[64:67], v[32:47]
    s_waitcnt lgkmcnt(7)
    v_mfma_f32_32x32x16_bf16 v[0:15], v[108:111], v[104:107], v[0:15]
    ds_read_b128 v[144:147], v179
    ds_read_b64_tr_b16 v[148:149], v184 offset:25600
    ds_read_b64_tr_b16 v[150:151], v184 offset:26368
    v_mfma_f32_16x16x32_bf16 v[100:103], v[108:111], v[96:99], v[100:103]
    ds_read_b64_tr_b16 v[152:153], v185 offset:25600
    ds_read_b64_tr_b16 v[154:155], v185 offset:26368
    v_mfma_f32_32x32x16_bf16 v[16:31], v[112:115], v[104:107], v[16:31]
    ds_read_b64_tr_b16 v[156:157], v186 offset:25600
    ds_read_b64_tr_b16 v[158:159], v186 offset:26368
    v_mfma_f32_32x32x16_bf16 v[32:47], v[116:119], v[104:107], v[32:47]
    s_waitcnt lgkmcnt(7)
    v_mfma_f32_32x32x16_bf16 v[0:15], v[128:131], v[124:127], v[0:15]
    s_add_u32 s50, s50, 1
    s_cmp_eq_u32 s50, 4
    s_cselect_b32 s47, s51, 32768
    s_cselect_b32 s50, 0, s50
    v_add_u32 v176, s47, v176
    v_add_u32 v177, s47, v177
    v_mfma_f32_16x16x32_bf16 v[100:103], v[128:131], v[96:99], v[100:103]
    v_add_u32 v178, s47, v178
    v_add_u32 v179, s47, v179
    v_add_u32 v184, s47, v184
    v_add_u32 v185, s47, v185
    v_add_u32 v186, s47, v186
    v_mfma_f32_32x32x16_bf16 v[16:31], v[132:135], v[124:127], v[16:31]
    s_waitcnt lgkmcnt(0)
    s_cmp_lg_u32 s46, 3
    s_cbranch_scc1 parallel_sum__sliding_block__dense_activation_gelu__prompt_kernel_noqf
    s_cmp_eq_u32 s5, 15
    s_cbranch_scc1 parallel_sum__sliding_block__dense_activation_gelu__prompt_kernel_noqf
    s_waitcnt vmcnt(0)
    v_mov_b32 v212, 163472
    v_mov_b32 v213, 1
    s_mov_b64 exec, 1
    ds_add_rtn_u32 v214, v212, v213
    s_waitcnt lgkmcnt(0)
    v_readfirstlane_b32 s32, v214
    s_cmp_eq_u32 s32, 3
    s_cbranch_scc0 parallel_sum__sliding_block__dense_activation_gelu__prompt_kernel_pq2
    v_mov_b32 v212, 0
    v_mov_b32 v213, s94
    buffer_store_dword v213, v212, s[20:23], s95 offen offset:0 sc1
parallel_sum__sliding_block__dense_activation_gelu__prompt_kernel_pq2:
    s_mov_b64 exec, -1
parallel_sum__sliding_block__dense_activation_gelu__prompt_kernel_noqf:
    s_barrier
    ds_read_b128 v[64:67], v176
    ds_read_b64_tr_b16 v[68:69], v184 offset:16384
    ds_read_b64_tr_b16 v[70:71], v184 offset:17152
    ds_read_b64_tr_b16 v[72:73], v185 offset:16384
    v_mfma_f32_32x32x16_bf16 v[32:47], v[136:139], v[124:127], v[32:47]
    ds_read_b64_tr_b16 v[74:75], v185 offset:17152
    ds_read_b64_tr_b16 v[76:77], v186 offset:16384
    ds_read_b64_tr_b16 v[78:79], v186 offset:17152
    v_mfma_f32_32x32x16_bf16 v[0:15], v[148:151], v[144:147], v[0:15]
    ds_read_b128 v[104:107], v177
    ds_read_b64_tr_b16 v[108:109], v184 offset:19456
    ds_read_b64_tr_b16 v[110:111], v184 offset:20224
    v_mfma_f32_16x16x32_bf16 v[100:103], v[148:151], v[96:99], v[100:103]
    ds_read_b64_tr_b16 v[112:113], v185 offset:19456
    ds_read_b64_tr_b16 v[114:115], v185 offset:20224
    v_mfma_f32_32x32x16_bf16 v[16:31], v[152:155], v[144:147], v[16:31]
    ds_read_b64_tr_b16 v[116:117], v186 offset:19456
    ds_read_b64_tr_b16 v[118:119], v186 offset:20224
    v_mfma_f32_32x32x16_bf16 v[32:47], v[156:159], v[144:147], v[32:47]
    s_add_u32 s46, s46, 1
    s_cmp_lt_u32 s46, 9
    s_cbranch_scc1 parallel_sum__sliding_block__dense_activation_gelu__prompt_kernel_p2
    s_waitcnt lgkmcnt(7)
    v_mfma_f32_32x32x16_bf16 v[0:15], v[68:71], v[64:67], v[0:15]
    ds_read_b128 v[124:127], v178
    ds_read_b64_tr_b16 v[128:129], v184 offset:22528
    ds_read_b64_tr_b16 v[130:131], v184 offset:23296
    v_mfma_f32_16x16x32_bf16 v[100:103], v[68:71], v[96:99], v[100:103]
    ds_read_b64_tr_b16 v[132:133], v185 offset:22528
    ds_read_b64_tr_b16 v[134:135], v185 offset:23296
    v_mfma_f32_32x32x16_bf16 v[16:31], v[72:75], v[64:67], v[16:31]
    ds_read_b64_tr_b16 v[136:137], v186 offset:22528
    ds_read_b64_tr_b16 v[138:139], v186 offset:23296
    v_mfma_f32_32x32x16_bf16 v[32:47], v[76:79], v[64:67], v[32:47]
    s_waitcnt lgkmcnt(7)
    v_mfma_f32_32x32x16_bf16 v[0:15], v[108:111], v[104:107], v[0:15]
    ds_read_b128 v[144:147], v179
    ds_read_b64_tr_b16 v[148:149], v184 offset:25600
    ds_read_b64_tr_b16 v[150:151], v184 offset:26368
    v_mfma_f32_16x16x32_bf16 v[100:103], v[108:111], v[96:99], v[100:103]
    ds_read_b64_tr_b16 v[152:153], v185 offset:25600
    ds_read_b64_tr_b16 v[154:155], v185 offset:26368
    v_mfma_f32_32x32x16_bf16 v[16:31], v[112:115], v[104:107], v[16:31]
    ds_read_b64_tr_b16 v[156:157], v186 offset:25600
    ds_read_b64_tr_b16 v[158:159], v186 offset:26368
    v_mfma_f32_32x32x16_bf16 v[32:47], v[116:119], v[104:107], v[32:47]
    s_waitcnt lgkmcnt(7)
    v_mfma_f32_32x32x16_bf16 v[0:15], v[128:131], v[124:127], v[0:15]
    v_mfma_f32_16x16x32_bf16 v[100:103], v[128:131], v[96:99], v[100:103]
    v_mfma_f32_32x32x16_bf16 v[16:31], v[132:135], v[124:127], v[16:31]
    v_mfma_f32_32x32x16_bf16 v[32:47], v[136:139], v[124:127], v[32:47]
    s_waitcnt lgkmcnt(0)
    v_mfma_f32_32x32x16_bf16 v[0:15], v[148:151], v[144:147], v[0:15]
    v_mfma_f32_16x16x32_bf16 v[100:103], v[148:151], v[96:99], v[100:103]
    v_mfma_f32_32x32x16_bf16 v[16:31], v[152:155], v[144:147], v[16:31]
    v_mfma_f32_32x32x16_bf16 v[32:47], v[156:159], v[144:147], v[32:47]
    s_add_u32 s50, s50, 1
    s_cmp_eq_u32 s50, 4
    s_cselect_b32 s47, s51, 32768
    s_cselect_b32 s50, 0, s50
    v_add_u32 v176, s47, v176
    v_add_u32 v177, s47, v177
    v_add_u32 v178, s47, v178
    v_add_u32 v179, s47, v179
    v_add_u32 v184, s47, v184
    v_add_u32 v185, s47, v185
    v_add_u32 v186, s47, v186
    v_lshl_add_u32 v196, v211, 5, v210
    v_and_b32 v197, 1, v196
    v_lshrrev_b32 v196, 4, v196
    v_lshlrev_b32 v196, 4, v196
    v_lshl_add_u32 v196, v197, 6, v196
    s_lshl_b32 s6, s58, 7
    s_add_u32 s6, s6, 161664
    v_add_u32 v196, s6, v196
    s_nop 7
    s_mov_b32 s32, 0x00030003
    s_mov_b32 s33, 0x00030003
    s_mov_b64 exec, s[32:33]
    ds_write_b128 v196, v[100:103]
    s_mov_b64 exec, -1
    s_waitcnt lgkmcnt(0)
    v_mov_b32 v212, 163492
    v_mov_b32 v213, 1
    s_mov_b64 exec, 1
    ds_add_u32 v212, v213
    s_mov_b64 exec, -1
    v_mov_b32 v212, 163492
    s_mov_b32 s33, 0
parallel_sum__sliding_block__dense_activation_gelu__prompt_kernel_we2:
    ds_read_b32 v213, v212
    s_waitcnt lgkmcnt(0)
    v_readfirstlane_b32 s32, v213
    s_cmp_ge_u32 s32, 4
    s_cbranch_scc1 parallel_sum__sliding_block__dense_activation_gelu__prompt_kernel_we2_ok
    s_sleep 1
    s_add_u32 s33, s33, 1
    s_cmp_lt_u32 s33, 1600000
    s_cbranch_scc1 parallel_sum__sliding_block__dense_activation_gelu__prompt_kernel_we2
parallel_sum__sliding_block__dense_activation_gelu__prompt_kernel_we2_ok:
    v_mov_b32 v212, 163488
    s_mov_b32 s33, 0
parallel_sum__sliding_block__dense_activation_gelu__prompt_kernel_wq:
    ds_read_b32 v213, v212
    s_waitcnt lgkmcnt(0)
    v_readfirstlane_b32 s32, v213
    s_cmp_ge_u32 s32, 1
    s_cbranch_scc1 parallel_sum__sliding_block__dense_activation_gelu__prompt_kernel_wq_ok
    s_sleep 1
    s_add_u32 s33, s33, 1
    s_cmp_lt_u32 s33, 1600000
    s_cbranch_scc1 parallel_sum__sliding_block__dense_activation_gelu__prompt_kernel_wq
parallel_sum__sliding_block__dense_activation_gelu__prompt_kernel_wq_ok:
    s_and_b32 s6, s2, 7
    s_lshr_b32 s7, s2, 3
    s_and_b32 s62, s7, 15
    s_lshr_b32 s7, s7, 4
    s_lshl_b32 s63, s6, 1
    s_add_u32 s63, s63, s7
    s_lshl_b32 s7, s3, 5
    v_add_u32 v196, s7, v210
    v_lshlrev_b32 v196, 4, v196
    v_lshl_add_u32 v197, v211, 3, v196
    v_lshl_add_u32 v196, v211, 11, v196
    s_mul_i32 s35, s62, 240
    s_mul_i32 s7, s63, 5
    s_add_u32 s35, s35, s7
    s_lshl_b32 s35, s35, 11
    s_add_u32 s35, s35, 9437184
    buffer_load_dwordx4 v[144:147], v196, s[20:23], s35 offen sc1
    s_add_u32 s7, s35, 6144
    buffer_load_dwordx4 v[152:155], v196, s[20:23], s7 offen sc1
    s_add_u32 s7, s35, 4096
    buffer_load_dwordx2 v[148:149], v197, s[20:23], s7 offen sc1
    s_mov_b32 s52, 0xc0135761
    s_mov_b32 s53, 0xbdd2d3e8
    s_mov_b32 s54, 1.0
    s_mov_b32 s55, 1.0
    v_lshl_add_u32 v195, v211, 5, v210
    v_lshlrev_b32 v195, 4, v195
    s_lshl_b32 s7, s4, 2
    s_add_u32 s7, s7, s3
    s_mul_i32 s7, s7, 136
    s_mul_i32 s6, s5, 6
    s_add_u32 s7, s7, s6
    s_add_u32 s7, s7, 40
    s_lshl_b32 s35, s7, 10
    s_lshl_b32 s6, s58, 7
    v_add_u32 v196, s6, v194
    s_lshl_b32 s6, s58, 11
    s_add_u32 s6, s6, s35
    ds_read_b128 v[112:115], v196 offset:512
    ds_read_b128 v[128:131], v196 offset:896
    ds_read_b128 v[116:119], v196 offset:544
    ds_read_b128 v[132:135], v196 offset:928
    ds_read_b128 v[120:123], v196 offset:576
    ds_read_b128 v[136:139], v196 offset:960
    ds_read_b128 v[124:127], v196 offset:608
    ds_read_b128 v[140:143], v196 offset:992
    s_waitcnt lgkmcnt(4)
    v_pk_fma_f32 v[112:113], v[112:113], v[190:191], v[128:129] op_sel:[0,1,0] op_sel_hi:[1,1,1]
    v_pk_fma_f32 v[114:115], v[114:115], v[190:191], v[130:131] op_sel:[0,1,0] op_sel_hi:[1,1,1]
    v_pk_fma_f32 v[0:1], v[0:1], v[190:191], v[112:113] op_sel:[0,0,0] op_sel_hi:[1,0,1]
    v_pk_fma_f32 v[2:3], v[2:3], v[190:191], v[114:115] op_sel:[0,0,0] op_sel_hi:[1,0,1]
    v_pk_fma_f32 v[116:117], v[116:117], v[190:191], v[132:133] op_sel:[0,1,0] op_sel_hi:[1,1,1]
    v_pk_fma_f32 v[118:119], v[118:119], v[190:191], v[134:135] op_sel:[0,1,0] op_sel_hi:[1,1,1]
    v_pk_fma_f32 v[4:5], v[4:5], v[190:191], v[116:117] op_sel:[0,0,0] op_sel_hi:[1,0,1]
    v_pk_fma_f32 v[6:7], v[6:7], v[190:191], v[118:119] op_sel:[0,0,0] op_sel_hi:[1,0,1]
    v_pk_mul_f32 v[202:203], v[0:1], v[0:1]
    v_pk_mul_f32 v[204:205], v[2:3], v[2:3]
    v_pk_mul_f32 v[206:207], v[4:5], v[4:5]
    v_pk_mul_f32 v[208:209], v[6:7], v[6:7]
    v_pk_fma_f32 v[202:203], v[202:203], s[52:53], s[52:53] op_sel:[0,1,0] op_sel_hi:[1,1,0]
    v_pk_fma_f32 v[204:205], v[204:205], s[52:53], s[52:53] op_sel:[0,1,0] op_sel_hi:[1,1,0]
    v_pk_fma_f32 v[206:207], v[206:207], s[52:53], s[52:53] op_sel:[0,1,0] op_sel_hi:[1,1,0]
    v_pk_fma_f32 v[208:209], v[208:209], s[52:53], s[52:53] op_sel:[0,1,0] op_sel_hi:[1,1,0]
    v_pk_mul_f32 v[202:203], v[202:203], v[0:1]
    v_pk_mul_f32 v[204:205], v[204:205], v[2:3]
    v_pk_mul_f32 v[206:207], v[206:207], v[4:5]
    v_pk_mul_f32 v[208:209], v[208:209], v[6:7]
    v_exp_f32 v202, v202
    v_exp_f32 v203, v203
    v_exp_f32 v204, v204
    v_exp_f32 v205, v205
    v_exp_f32 v206, v206
    v_exp_f32 v207, v207
    v_exp_f32 v208, v208
    v_exp_f32 v209, v209
    v_pk_add_f32 v[202:203], v[202:203], s[54:55]
    v_pk_add_f32 v[204:205], v[204:205], s[54:55]
    v_pk_add_f32 v[206:207], v[206:207], s[54:55]
    v_pk_add_f32 v[208:209], v[208:209], s[54:55]
    v_rcp_f32 v202, v202
    v_rcp_f32 v203, v203
    v_rcp_f32 v204, v204
    v_rcp_f32 v205, v205
    v_rcp_f32 v206, v206
    v_rcp_f32 v207, v207
    v_rcp_f32 v208, v208
    v_rcp_f32 v209, v209
    v_pk_mul_f32 v[0:1], v[0:1], v[202:203]
    v_pk_mul_f32 v[2:3], v[2:3], v[204:205]
    v_pk_mul_f32 v[4:5], v[4:5], v[206:207]
    v_pk_mul_f32 v[6:7], v[6:7], v[208:209]
    v_cvt_pk_bf16_f32 v160, v0, v1
    v_cvt_pk_bf16_f32 v161, v2, v3
    v_cvt_pk_bf16_f32 v162, v4, v5
    v_cvt_pk_bf16_f32 v163, v6, v7
    s_waitcnt lgkmcnt(0)
    v_pk_fma_f32 v[120:121], v[120:121], v[190:191], v[136:137] op_sel:[0,1,0] op_sel_hi:[1,1,1]
    v_pk_fma_f32 v[122:123], v[122:123], v[190:191], v[138:139] op_sel:[0,1,0] op_sel_hi:[1,1,1]
    v_pk_fma_f32 v[8:9], v[8:9], v[190:191], v[120:121] op_sel:[0,0,0] op_sel_hi:[1,0,1]
    v_pk_fma_f32 v[10:11], v[10:11], v[190:191], v[122:123] op_sel:[0,0,0] op_sel_hi:[1,0,1]
    v_pk_fma_f32 v[124:125], v[124:125], v[190:191], v[140:141] op_sel:[0,1,0] op_sel_hi:[1,1,1]
    v_pk_fma_f32 v[126:127], v[126:127], v[190:191], v[142:143] op_sel:[0,1,0] op_sel_hi:[1,1,1]
    v_pk_fma_f32 v[12:13], v[12:13], v[190:191], v[124:125] op_sel:[0,0,0] op_sel_hi:[1,0,1]
    v_pk_fma_f32 v[14:15], v[14:15], v[190:191], v[126:127] op_sel:[0,0,0] op_sel_hi:[1,0,1]
    v_pk_mul_f32 v[202:203], v[8:9], v[8:9]
    v_pk_mul_f32 v[204:205], v[10:11], v[10:11]
    v_pk_mul_f32 v[206:207], v[12:13], v[12:13]
    v_pk_mul_f32 v[208:209], v[14:15], v[14:15]
    v_pk_fma_f32 v[202:203], v[202:203], s[52:53], s[52:53] op_sel:[0,1,0] op_sel_hi:[1,1,0]
    v_pk_fma_f32 v[204:205], v[204:205], s[52:53], s[52:53] op_sel:[0,1,0] op_sel_hi:[1,1,0]
    v_pk_fma_f32 v[206:207], v[206:207], s[52:53], s[52:53] op_sel:[0,1,0] op_sel_hi:[1,1,0]
    v_pk_fma_f32 v[208:209], v[208:209], s[52:53], s[52:53] op_sel:[0,1,0] op_sel_hi:[1,1,0]
    v_pk_mul_f32 v[202:203], v[202:203], v[8:9]
    v_pk_mul_f32 v[204:205], v[204:205], v[10:11]
    v_pk_mul_f32 v[206:207], v[206:207], v[12:13]
    v_pk_mul_f32 v[208:209], v[208:209], v[14:15]
    v_exp_f32 v202, v202
    v_exp_f32 v203, v203
    v_exp_f32 v204, v204
    v_exp_f32 v205, v205
    v_exp_f32 v206, v206
    v_exp_f32 v207, v207
    v_exp_f32 v208, v208
    v_exp_f32 v209, v209
    v_pk_add_f32 v[202:203], v[202:203], s[54:55]
    v_pk_add_f32 v[204:205], v[204:205], s[54:55]
    v_pk_add_f32 v[206:207], v[206:207], s[54:55]
    v_pk_add_f32 v[208:209], v[208:209], s[54:55]
    v_rcp_f32 v202, v202
    v_rcp_f32 v203, v203
    v_rcp_f32 v204, v204
    v_rcp_f32 v205, v205
    v_rcp_f32 v206, v206
    v_rcp_f32 v207, v207
    v_rcp_f32 v208, v208
    v_rcp_f32 v209, v209
    v_pk_mul_f32 v[8:9], v[8:9], v[202:203]
    v_pk_mul_f32 v[10:11], v[10:11], v[204:205]
    v_pk_mul_f32 v[12:13], v[12:13], v[206:207]
    v_pk_mul_f32 v[14:15], v[14:15], v[208:209]
    v_cvt_pk_bf16_f32 v164, v8, v9
    v_cvt_pk_bf16_f32 v165, v10, v11
    v_cvt_pk_bf16_f32 v166, v12, v13
    v_cvt_pk_bf16_f32 v167, v14, v15
    s_nop 1
    v_permlane32_swap_b32 v160, v162
    v_permlane32_swap_b32 v161, v163
    v_permlane32_swap_b32 v164, v166
    v_permlane32_swap_b32 v165, v167
    buffer_store_dwordx4 v[160:163], v195, s[20:23], s6 offen offset:0 sc1
    buffer_store_dwordx4 v[164:167], v195, s[20:23], s6 offen offset:1024 sc1
    s_lshl_b32 s6, s59, 7
    v_add_u32 v196, s6, v194
    s_lshl_b32 s6, s59, 11
    s_add_u32 s6, s6, s35
    ds_read_b128 v[112:115], v196 offset:512
    ds_read_b128 v[128:131], v196 offset:896
    ds_read_b128 v[116:119], v196 offset:544
    ds_read_b128 v[132:135], v196 offset:928
    ds_read_b128 v[120:123], v196 offset:576
    ds_read_b128 v[136:139], v196 offset:960
    ds_read_b128 v[124:127], v196 offset:608
    ds_read_b128 v[140:143], v196 offset:992
    s_waitcnt lgkmcnt(4)
    v_pk_fma_f32 v[112:113], v[112:113], v[190:191], v[128:129] op_sel:[0,1,0] op_sel_hi:[1,1,1]
    v_pk_fma_f32 v[114:115], v[114:115], v[190:191], v[130:131] op_sel:[0,1,0] op_sel_hi:[1,1,1]
    v_pk_fma_f32 v[16:17], v[16:17], v[190:191], v[112:113] op_sel:[0,0,0] op_sel_hi:[1,0,1]
    v_pk_fma_f32 v[18:19], v[18:19], v[190:191], v[114:115] op_sel:[0,0,0] op_sel_hi:[1,0,1]
    v_pk_fma_f32 v[116:117], v[116:117], v[190:191], v[132:133] op_sel:[0,1,0] op_sel_hi:[1,1,1]
    v_pk_fma_f32 v[118:119], v[118:119], v[190:191], v[134:135] op_sel:[0,1,0] op_sel_hi:[1,1,1]
    v_pk_fma_f32 v[20:21], v[20:21], v[190:191], v[116:117] op_sel:[0,0,0] op_sel_hi:[1,0,1]
    v_pk_fma_f32 v[22:23], v[22:23], v[190:191], v[118:119] op_sel:[0,0,0] op_sel_hi:[1,0,1]
    v_pk_mul_f32 v[202:203], v[16:17], v[16:17]
    v_pk_mul_f32 v[204:205], v[18:19], v[18:19]
    v_pk_mul_f32 v[206:207], v[20:21], v[20:21]
    v_pk_mul_f32 v[208:209], v[22:23], v[22:23]
    v_pk_fma_f32 v[202:203], v[202:203], s[52:53], s[52:53] op_sel:[0,1,0] op_sel_hi:[1,1,0]
    v_pk_fma_f32 v[204:205], v[204:205], s[52:53], s[52:53] op_sel:[0,1,0] op_sel_hi:[1,1,0]
    v_pk_fma_f32 v[206:207], v[206:207], s[52:53], s[52:53] op_sel:[0,1,0] op_sel_hi:[1,1,0]
    v_pk_fma_f32 v[208:209], v[208:209], s[52:53], s[52:53] op_sel:[0,1,0] op_sel_hi:[1,1,0]
    v_pk_mul_f32 v[202:203], v[202:203], v[16:17]
    v_pk_mul_f32 v[204:205], v[204:205], v[18:19]
    v_pk_mul_f32 v[206:207], v[206:207], v[20:21]
    v_pk_mul_f32 v[208:209], v[208:209], v[22:23]
    v_exp_f32 v202, v202
    v_exp_f32 v203, v203
    v_exp_f32 v204, v204
    v_exp_f32 v205, v205
    v_exp_f32 v206, v206
    v_exp_f32 v207, v207
    v_exp_f32 v208, v208
    v_exp_f32 v209, v209
    v_pk_add_f32 v[202:203], v[202:203], s[54:55]
    v_pk_add_f32 v[204:205], v[204:205], s[54:55]
    v_pk_add_f32 v[206:207], v[206:207], s[54:55]
    v_pk_add_f32 v[208:209], v[208:209], s[54:55]
    v_rcp_f32 v202, v202
    v_rcp_f32 v203, v203
    v_rcp_f32 v204, v204
    v_rcp_f32 v205, v205
    v_rcp_f32 v206, v206
    v_rcp_f32 v207, v207
    v_rcp_f32 v208, v208
    v_rcp_f32 v209, v209
    v_pk_mul_f32 v[16:17], v[16:17], v[202:203]
    v_pk_mul_f32 v[18:19], v[18:19], v[204:205]
    v_pk_mul_f32 v[20:21], v[20:21], v[206:207]
    v_pk_mul_f32 v[22:23], v[22:23], v[208:209]
    v_cvt_pk_bf16_f32 v160, v16, v17
    v_cvt_pk_bf16_f32 v161, v18, v19
    v_cvt_pk_bf16_f32 v162, v20, v21
    v_cvt_pk_bf16_f32 v163, v22, v23
    s_waitcnt lgkmcnt(0)
    v_pk_fma_f32 v[120:121], v[120:121], v[190:191], v[136:137] op_sel:[0,1,0] op_sel_hi:[1,1,1]
    v_pk_fma_f32 v[122:123], v[122:123], v[190:191], v[138:139] op_sel:[0,1,0] op_sel_hi:[1,1,1]
    v_pk_fma_f32 v[24:25], v[24:25], v[190:191], v[120:121] op_sel:[0,0,0] op_sel_hi:[1,0,1]
    v_pk_fma_f32 v[26:27], v[26:27], v[190:191], v[122:123] op_sel:[0,0,0] op_sel_hi:[1,0,1]
    v_pk_fma_f32 v[124:125], v[124:125], v[190:191], v[140:141] op_sel:[0,1,0] op_sel_hi:[1,1,1]
    v_pk_fma_f32 v[126:127], v[126:127], v[190:191], v[142:143] op_sel:[0,1,0] op_sel_hi:[1,1,1]
    v_pk_fma_f32 v[28:29], v[28:29], v[190:191], v[124:125] op_sel:[0,0,0] op_sel_hi:[1,0,1]
    v_pk_fma_f32 v[30:31], v[30:31], v[190:191], v[126:127] op_sel:[0,0,0] op_sel_hi:[1,0,1]
    v_pk_mul_f32 v[202:203], v[24:25], v[24:25]
    v_pk_mul_f32 v[204:205], v[26:27], v[26:27]
    v_pk_mul_f32 v[206:207], v[28:29], v[28:29]
    v_pk_mul_f32 v[208:209], v[30:31], v[30:31]
    v_pk_fma_f32 v[202:203], v[202:203], s[52:53], s[52:53] op_sel:[0,1,0] op_sel_hi:[1,1,0]
    v_pk_fma_f32 v[204:205], v[204:205], s[52:53], s[52:53] op_sel:[0,1,0] op_sel_hi:[1,1,0]
    v_pk_fma_f32 v[206:207], v[206:207], s[52:53], s[52:53] op_sel:[0,1,0] op_sel_hi:[1,1,0]
    v_pk_fma_f32 v[208:209], v[208:209], s[52:53], s[52:53] op_sel:[0,1,0] op_sel_hi:[1,1,0]
    v_pk_mul_f32 v[202:203], v[202:203], v[24:25]
    v_pk_mul_f32 v[204:205], v[204:205], v[26:27]
    v_pk_mul_f32 v[206:207], v[206:207], v[28:29]
    v_pk_mul_f32 v[208:209], v[208:209], v[30:31]
    v_exp_f32 v202, v202
    v_exp_f32 v203, v203
    v_exp_f32 v204, v204
    v_exp_f32 v205, v205
    v_exp_f32 v206, v206
    v_exp_f32 v207, v207
    v_exp_f32 v208, v208
    v_exp_f32 v209, v209
    v_pk_add_f32 v[202:203], v[202:203], s[54:55]
    v_pk_add_f32 v[204:205], v[204:205], s[54:55]
    v_pk_add_f32 v[206:207], v[206:207], s[54:55]
    v_pk_add_f32 v[208:209], v[208:209], s[54:55]
    v_rcp_f32 v202, v202
    v_rcp_f32 v203, v203
    v_rcp_f32 v204, v204
    v_rcp_f32 v205, v205
    v_rcp_f32 v206, v206
    v_rcp_f32 v207, v207
    v_rcp_f32 v208, v208
    v_rcp_f32 v209, v209
    v_pk_mul_f32 v[24:25], v[24:25], v[202:203]
    v_pk_mul_f32 v[26:27], v[26:27], v[204:205]
    v_pk_mul_f32 v[28:29], v[28:29], v[206:207]
    v_pk_mul_f32 v[30:31], v[30:31], v[208:209]
    v_cvt_pk_bf16_f32 v164, v24, v25
    v_cvt_pk_bf16_f32 v165, v26, v27
    v_cvt_pk_bf16_f32 v166, v28, v29
    v_cvt_pk_bf16_f32 v167, v30, v31
    s_nop 1
    v_permlane32_swap_b32 v160, v162
    v_permlane32_swap_b32 v161, v163
    v_permlane32_swap_b32 v164, v166
    v_permlane32_swap_b32 v165, v167
    buffer_store_dwordx4 v[160:163], v195, s[20:23], s6 offen offset:0 sc1
    buffer_store_dwordx4 v[164:167], v195, s[20:23], s6 offen offset:1024 sc1
    s_lshl_b32 s6, s60, 7
    v_add_u32 v196, s6, v194
    s_lshl_b32 s6, s60, 11
    s_add_u32 s6, s6, s35
    ds_read_b128 v[112:115], v196 offset:512
    ds_read_b128 v[128:131], v196 offset:896
    ds_read_b128 v[116:119], v196 offset:544
    ds_read_b128 v[132:135], v196 offset:928
    ds_read_b128 v[120:123], v196 offset:576
    ds_read_b128 v[136:139], v196 offset:960
    ds_read_b128 v[124:127], v196 offset:608
    ds_read_b128 v[140:143], v196 offset:992
    s_waitcnt lgkmcnt(4)
    v_pk_fma_f32 v[112:113], v[112:113], v[190:191], v[128:129] op_sel:[0,1,0] op_sel_hi:[1,1,1]
    v_pk_fma_f32 v[114:115], v[114:115], v[190:191], v[130:131] op_sel:[0,1,0] op_sel_hi:[1,1,1]
    v_pk_fma_f32 v[32:33], v[32:33], v[190:191], v[112:113] op_sel:[0,0,0] op_sel_hi:[1,0,1]
    v_pk_fma_f32 v[34:35], v[34:35], v[190:191], v[114:115] op_sel:[0,0,0] op_sel_hi:[1,0,1]
    v_pk_fma_f32 v[116:117], v[116:117], v[190:191], v[132:133] op_sel:[0,1,0] op_sel_hi:[1,1,1]
    v_pk_fma_f32 v[118:119], v[118:119], v[190:191], v[134:135] op_sel:[0,1,0] op_sel_hi:[1,1,1]
    v_pk_fma_f32 v[36:37], v[36:37], v[190:191], v[116:117] op_sel:[0,0,0] op_sel_hi:[1,0,1]
    v_pk_fma_f32 v[38:39], v[38:39], v[190:191], v[118:119] op_sel:[0,0,0] op_sel_hi:[1,0,1]
    v_pk_mul_f32 v[202:203], v[32:33], v[32:33]
    v_pk_mul_f32 v[204:205], v[34:35], v[34:35]
    v_pk_mul_f32 v[206:207], v[36:37], v[36:37]
    v_pk_mul_f32 v[208:209], v[38:39], v[38:39]
    v_pk_fma_f32 v[202:203], v[202:203], s[52:53], s[52:53] op_sel:[0,1,0] op_sel_hi:[1,1,0]
    v_pk_fma_f32 v[204:205], v[204:205], s[52:53], s[52:53] op_sel:[0,1,0] op_sel_hi:[1,1,0]
    v_pk_fma_f32 v[206:207], v[206:207], s[52:53], s[52:53] op_sel:[0,1,0] op_sel_hi:[1,1,0]
    v_pk_fma_f32 v[208:209], v[208:209], s[52:53], s[52:53] op_sel:[0,1,0] op_sel_hi:[1,1,0]
    v_pk_mul_f32 v[202:203], v[202:203], v[32:33]
    v_pk_mul_f32 v[204:205], v[204:205], v[34:35]
    v_pk_mul_f32 v[206:207], v[206:207], v[36:37]
    v_pk_mul_f32 v[208:209], v[208:209], v[38:39]
    v_exp_f32 v202, v202
    v_exp_f32 v203, v203
    v_exp_f32 v204, v204
    v_exp_f32 v205, v205
    v_exp_f32 v206, v206
    v_exp_f32 v207, v207
    v_exp_f32 v208, v208
    v_exp_f32 v209, v209
    v_pk_add_f32 v[202:203], v[202:203], s[54:55]
    v_pk_add_f32 v[204:205], v[204:205], s[54:55]
    v_pk_add_f32 v[206:207], v[206:207], s[54:55]
    v_pk_add_f32 v[208:209], v[208:209], s[54:55]
    v_rcp_f32 v202, v202
    v_rcp_f32 v203, v203
    v_rcp_f32 v204, v204
    v_rcp_f32 v205, v205
    v_rcp_f32 v206, v206
    v_rcp_f32 v207, v207
    v_rcp_f32 v208, v208
    v_rcp_f32 v209, v209
    v_pk_mul_f32 v[32:33], v[32:33], v[202:203]
    v_pk_mul_f32 v[34:35], v[34:35], v[204:205]
    v_pk_mul_f32 v[36:37], v[36:37], v[206:207]
    v_pk_mul_f32 v[38:39], v[38:39], v[208:209]
    v_cvt_pk_bf16_f32 v160, v32, v33
    v_cvt_pk_bf16_f32 v161, v34, v35
    v_cvt_pk_bf16_f32 v162, v36, v37
    v_cvt_pk_bf16_f32 v163, v38, v39
    s_waitcnt lgkmcnt(0)
    v_pk_fma_f32 v[120:121], v[120:121], v[190:191], v[136:137] op_sel:[0,1,0] op_sel_hi:[1,1,1]
    v_pk_fma_f32 v[122:123], v[122:123], v[190:191], v[138:139] op_sel:[0,1,0] op_sel_hi:[1,1,1]
    v_pk_fma_f32 v[40:41], v[40:41], v[190:191], v[120:121] op_sel:[0,0,0] op_sel_hi:[1,0,1]
    v_pk_fma_f32 v[42:43], v[42:43], v[190:191], v[122:123] op_sel:[0,0,0] op_sel_hi:[1,0,1]
    v_pk_fma_f32 v[124:125], v[124:125], v[190:191], v[140:141] op_sel:[0,1,0] op_sel_hi:[1,1,1]
    v_pk_fma_f32 v[126:127], v[126:127], v[190:191], v[142:143] op_sel:[0,1,0] op_sel_hi:[1,1,1]
    v_pk_fma_f32 v[44:45], v[44:45], v[190:191], v[124:125] op_sel:[0,0,0] op_sel_hi:[1,0,1]
    v_pk_fma_f32 v[46:47], v[46:47], v[190:191], v[126:127] op_sel:[0,0,0] op_sel_hi:[1,0,1]
    v_pk_mul_f32 v[202:203], v[40:41], v[40:41]
    v_pk_mul_f32 v[204:205], v[42:43], v[42:43]
    v_pk_mul_f32 v[206:207], v[44:45], v[44:45]
    v_pk_mul_f32 v[208:209], v[46:47], v[46:47]
    v_pk_fma_f32 v[202:203], v[202:203], s[52:53], s[52:53] op_sel:[0,1,0] op_sel_hi:[1,1,0]
    v_pk_fma_f32 v[204:205], v[204:205], s[52:53], s[52:53] op_sel:[0,1,0] op_sel_hi:[1,1,0]
    v_pk_fma_f32 v[206:207], v[206:207], s[52:53], s[52:53] op_sel:[0,1,0] op_sel_hi:[1,1,0]
    v_pk_fma_f32 v[208:209], v[208:209], s[52:53], s[52:53] op_sel:[0,1,0] op_sel_hi:[1,1,0]
    v_pk_mul_f32 v[202:203], v[202:203], v[40:41]
    v_pk_mul_f32 v[204:205], v[204:205], v[42:43]
    v_pk_mul_f32 v[206:207], v[206:207], v[44:45]
    v_pk_mul_f32 v[208:209], v[208:209], v[46:47]
    v_exp_f32 v202, v202
    v_exp_f32 v203, v203
    v_exp_f32 v204, v204
    v_exp_f32 v205, v205
    v_exp_f32 v206, v206
    v_exp_f32 v207, v207
    v_exp_f32 v208, v208
    v_exp_f32 v209, v209
    v_pk_add_f32 v[202:203], v[202:203], s[54:55]
    v_pk_add_f32 v[204:205], v[204:205], s[54:55]
    v_pk_add_f32 v[206:207], v[206:207], s[54:55]
    v_pk_add_f32 v[208:209], v[208:209], s[54:55]
    v_rcp_f32 v202, v202
    v_rcp_f32 v203, v203
    v_rcp_f32 v204, v204
    v_rcp_f32 v205, v205
    v_rcp_f32 v206, v206
    v_rcp_f32 v207, v207
    v_rcp_f32 v208, v208
    v_rcp_f32 v209, v209
    v_pk_mul_f32 v[40:41], v[40:41], v[202:203]
    v_pk_mul_f32 v[42:43], v[42:43], v[204:205]
    v_pk_mul_f32 v[44:45], v[44:45], v[206:207]
    v_pk_mul_f32 v[46:47], v[46:47], v[208:209]
    v_cvt_pk_bf16_f32 v164, v40, v41
    v_cvt_pk_bf16_f32 v165, v42, v43
    v_cvt_pk_bf16_f32 v166, v44, v45
    v_cvt_pk_bf16_f32 v167, v46, v47
    s_nop 1
    v_permlane32_swap_b32 v160, v162
    v_permlane32_swap_b32 v161, v163
    v_permlane32_swap_b32 v164, v166
    v_permlane32_swap_b32 v165, v167
    buffer_store_dwordx4 v[160:163], v195, s[20:23], s6 offen offset:0 sc1
    buffer_store_dwordx4 v[164:167], v195, s[20:23], s6 offen offset:1024 sc1
    s_nop 2
    v_lshl_add_u32 v0, v211, 5, v210
    s_mov_b32 s4, s62
    s_mov_b32 s5, s63
    v_and_b32 v164, 31, v0
    v_lshrrev_b32 v165, 5, v0
    v_lshlrev_b32 v166, 2, v165
    v_sub_u32 v166, v164, v166
    v_cmp_gt_i32 s[44:45], 0, v166
    v_cmp_gt_i32 s[46:47], 1, v166
    v_cmp_gt_i32 s[48:49], 2, v166
    v_cmp_gt_i32 s[50:51], 3, v166
    v_cmp_gt_i32 s[52:53], 8, v166
    v_cmp_gt_i32 s[54:55], 9, v166
    v_cmp_gt_i32 s[56:57], 10, v166
    v_cmp_gt_i32 s[58:59], 11, v166
    v_cmp_gt_i32 s[60:61], 16, v166
    v_cmp_gt_i32 s[62:63], 17, v166
    v_cmp_gt_i32 s[64:65], 18, v166
    v_cmp_gt_i32 s[66:67], 19, v166
    v_cmp_gt_i32 s[68:69], 24, v166
    v_cmp_gt_i32 s[70:71], 25, v166
    v_cmp_gt_i32 s[72:73], 26, v166
    v_cmp_gt_i32 s[74:75], 27, v166
    v_mul_u32_u24 v166, 6208, v165
    v_lshl_add_u32 v160, v164, 3, v166
    v_add_u32 v160, 98304, v160
    v_mul_u32_u24 v166, 3104, v165
    v_lshl_add_u32 v161, v164, 3, v166
    v_add_u32 v161, 110720, v161
    v_and_b32 v166, 3, v0
    v_bfe_u32 v167, v0, 4, 1
    v_lshl_add_u32 v166, v167, 2, v166
    v_bfe_u32 v167, v0, 2, 2
    v_lshl_add_u32 v167, v165, 2, v167
    v_lshlrev_b32 v167, 3, v167
    v_mul_u32_u24 v168, 3104, v166
    v_add_u32 v169, 129344, v168
    v_add_u32 v170, 147968, v168
    v_cmp_gt_u32 vcc, 5, v166
    v_mov_b32 v171, 160480
    v_mov_b32 v172, 160896
    v_cndmask_b32 v169, v171, v169, vcc
    v_mov_b32 v171, 256
    v_cndmask_b32 v190, 0, v171, vcc
    v_cmp_gt_u32 vcc, 4, v166
    v_cndmask_b32 v170, v172, v170, vcc
    v_cndmask_b32 v191, 0, v171, vcc
    v_mov_b32 v172, 144864
    v_cmp_eq_u32 vcc, 5, v166
    v_cndmask_b32 v170, v170, v172, vcc
    v_cndmask_b32 v191, v191, v171, vcc
    v_add_u32 v162, v169, v167
    v_add_u32 v163, v170, v167
    v_lshlrev_b32 v166, 3, v164
    v_mov_b32 v168, 0x3f80
    v_mov_b32 v169, 0
    v_add_u32 v167, 160480, v166
    ds_write_b64 v167, v[168:169]
    ds_write_b64 v167, v[168:169] offset:416
    s_waitcnt vmcnt(6)
    v_cmp_eq_u32 s[32:33], 0, v165
    v_mov_b32 v150, 0
    v_mov_b32 v151, 0
    v_mov_b32 v158, 0
    v_mov_b32 v159, 0
    v_mov_b32 v118, 0
    v_mov_b32 v119, 0
    v_mov_b32 v126, 0
    v_mov_b32 v127, 0
    v_cndmask_b32 v156, v148, 0, s[32:33]
    v_cndmask_b32 v157, v149, 0, s[32:33]
    v_cndmask_b32 v148, 0, v148, s[32:33]
    v_cndmask_b32 v149, 0, v149, s[32:33]
    s_mov_b32 s42, s3
    s_add_u32 s41, s3, 8
    s_lshl_b32 s6, s4, 2
    s_sub_i32 s6, 8, s6
    s_max_i32 s39, s6, s3
    s_lshl_b32 s6, s39, 8
    v_add_u32 v160, s6, v160
    v_add_u32 v161, s6, v161
    v_mul_u32_u24 v172, s39, v190
    v_add_u32 v162, v172, v162
    v_mul_u32_u24 v172, s39, v191
    v_add_u32 v163, v172, v163
    s_mov_b32 s43, 0
    v_mov_b32 v64, 0
    v_mov_b32 v65, 0
    v_mov_b32 v66, 0
    v_mov_b32 v67, 0
    v_mov_b32 v68, 0
    v_mov_b32 v69, 0
    v_mov_b32 v70, 0
    v_mov_b32 v71, 0
    v_mov_b32 v72, 0
    v_mov_b32 v73, 0
    v_mov_b32 v74, 0
    v_mov_b32 v75, 0
    v_mov_b32 v76, 0
    v_mov_b32 v77, 0
    v_mov_b32 v78, 0
    v_mov_b32 v79, 0
    v_mov_b32 v80, 0
    v_mov_b32 v81, 0
    v_mov_b32 v82, 0
    v_mov_b32 v83, 0
    v_mov_b32 v84, 0
    v_mov_b32 v85, 0
    v_mov_b32 v86, 0
    v_mov_b32 v87, 0
    v_mov_b32 v88, 0
    v_mov_b32 v89, 0
    v_mov_b32 v90, 0
    v_mov_b32 v91, 0
    v_mov_b32 v92, 0
    v_mov_b32 v93, 0
    v_mov_b32 v94, 0
    v_mov_b32 v95, 0
    v_mov_b32 v0, 0
    v_mov_b32 v1, 0
    v_mov_b32 v2, 0
    v_mov_b32 v3, 0
    v_mov_b32 v4, 0
    v_mov_b32 v5, 0
    v_mov_b32 v6, 0
    v_mov_b32 v7, 0
    v_mov_b32 v8, 0
    v_mov_b32 v9, 0
    v_mov_b32 v10, 0
    v_mov_b32 v11, 0
    v_mov_b32 v12, 0
    v_mov_b32 v13, 0
    v_mov_b32 v14, 0
    v_mov_b32 v15, 0
    v_mov_b32 v16, 0
    v_mov_b32 v17, 0
    v_mov_b32 v18, 0
    v_mov_b32 v19, 0
    v_mov_b32 v20, 0
    v_mov_b32 v21, 0
    v_mov_b32 v22, 0
    v_mov_b32 v23, 0
    v_mov_b32 v24, 0
    v_mov_b32 v25, 0
    v_mov_b32 v26, 0
    v_mov_b32 v27, 0
    v_mov_b32 v28, 0
    v_mov_b32 v29, 0
    v_mov_b32 v30, 0
    v_mov_b32 v31, 0
    v_mov_b32 v104, 0
    v_mov_b32 v136, 0
    v_mov_b32 v105, 0
    v_mov_b32 v137, 0
    v_mov_b32 v106, 0
    v_mov_b32 v138, 0
    v_mov_b32 v107, 0
    v_mov_b32 v139, 0
    v_mov_b32 v108, 0
    v_mov_b32 v140, 0
    v_mov_b32 v109, 0
    v_mov_b32 v141, 0
    v_mov_b32 v110, 0
    v_mov_b32 v142, 0
    v_mov_b32 v111, 0
    v_mov_b32 v143, 0
    s_mov_b32 s40, s39
    s_waitcnt vmcnt(0) lgkmcnt(0)
    v_mov_b32 v212, 163476
    v_mov_b32 v213, 1
    s_mov_b64 exec, 1
    ds_add_rtn_u32 v214, v212, v213
    s_waitcnt lgkmcnt(0)
    v_readfirstlane_b32 s32, v214
    s_cmp_eq_u32 s32, 3
    s_cbranch_scc0 parallel_sum__sliding_block__dense_activation_gelu__prompt_kernel_ph
    v_mov_b32 v212, 0
    v_mov_b32 v213, s94
    buffer_store_dword v213, v212, s[20:23], s95 offen offset:64 sc1
parallel_sum__sliding_block__dense_activation_gelu__prompt_kernel_ph:
    s_mov_b64 exec, -1
    v_mov_b32 v212, 163480
    s_mov_b32 s33, 0
parallel_sum__sliding_block__dense_activation_gelu__prompt_kernel_wkv:
    ds_read_b32 v213, v212
    s_waitcnt lgkmcnt(0)
    v_readfirstlane_b32 s32, v213
    s_cmp_ge_u32 s32, 4
    s_cbranch_scc1 parallel_sum__sliding_block__dense_activation_gelu__prompt_kernel_wkv_ok
    s_sleep 1
    s_add_u32 s33, s33, 1
    s_cmp_lt_u32 s33, 1600000
    s_cbranch_scc1 parallel_sum__sliding_block__dense_activation_gelu__prompt_kernel_wkv
parallel_sum__sliding_block__dense_activation_gelu__prompt_kernel_wkv_ok:
    s_branch parallel_sum__sliding_block__dense_activation_gelu__prompt_kernel_a_first
parallel_sum__sliding_block__dense_activation_gelu__prompt_kernel_a_restart:
    v_mov_b32 v0, 0
    v_mov_b32 v1, 0
    v_mov_b32 v2, 0
    v_mov_b32 v3, 0
    v_mov_b32 v4, 0
    v_mov_b32 v5, 0
    v_mov_b32 v6, 0
    v_mov_b32 v7, 0
    v_mov_b32 v8, 0
    v_mov_b32 v9, 0
    v_mov_b32 v10, 0
    v_mov_b32 v11, 0
    v_mov_b32 v12, 0
    v_mov_b32 v13, 0
    v_mov_b32 v14, 0
    v_mov_b32 v15, 0
    v_mov_b32 v16, 0
    v_mov_b32 v17, 0
    v_mov_b32 v18, 0
    v_mov_b32 v19, 0
    v_mov_b32 v20, 0
    v_mov_b32 v21, 0
    v_mov_b32 v22, 0
    v_mov_b32 v23, 0
    v_mov_b32 v24, 0
    v_mov_b32 v25, 0
    v_mov_b32 v26, 0
    v_mov_b32 v27, 0
    v_mov_b32 v28, 0
    v_mov_b32 v29, 0
    v_mov_b32 v30, 0
    v_mov_b32 v31, 0
    v_mov_b32 v104, 0
    v_mov_b32 v136, 0
    v_mov_b32 v105, 0
    v_mov_b32 v137, 0
    v_mov_b32 v106, 0
    v_mov_b32 v138, 0
    v_mov_b32 v107, 0
    v_mov_b32 v139, 0
    v_mov_b32 v108, 0
    v_mov_b32 v140, 0
    v_mov_b32 v109, 0
    v_mov_b32 v141, 0
    v_mov_b32 v110, 0
    v_mov_b32 v142, 0
    v_mov_b32 v111, 0
    v_mov_b32 v143, 0
    s_mov_b32 s40, s39
parallel_sum__sliding_block__dense_activation_gelu__prompt_kernel_a_first:
    ds_read_b64 v[112:113], v160 offset:0
    ds_read_b64 v[114:115], v160 offset:3104
    ds_read_b64 v[116:117], v161 offset:0
    ds_read_b64 v[120:121], v160 offset:18624
    ds_read_b64 v[122:123], v160 offset:21728
    ds_read_b64 v[124:125], v161 offset:0
    s_waitcnt lgkmcnt(3)
    v_mfma_f32_32x32x16_bf16 v[32:47], v[112:115], v[144:147], v[64:79]
    v_mfma_f32_32x32x16_bf16 v[32:47], v[116:119], v[148:151], v[32:47]
    s_waitcnt lgkmcnt(0)
    s_nop 7
    s_nop 7
    s_cmp_eq_u32 s40, s42
    s_cselect_b32 s38, 1, 0
    s_cmp_eq_u32 s40, s41
    s_cselect_b32 s38, 1, s38
parallel_sum__sliding_block__dense_activation_gelu__prompt_kernel_a_loop:
    ds_read_b64_tr_b16 v[128:129], v162 offset:0
    ds_read_b64_tr_b16 v[130:131], v162 offset:64
    ds_read_b64_tr_b16 v[132:133], v162 offset:128
    ds_read_b64_tr_b16 v[134:135], v162 offset:192
    ds_read_b64 v[112:113], v160 offset:256
    ds_read_b64 v[114:115], v160 offset:3360
    ds_read_b64 v[116:117], v161 offset:256
    s_waitcnt lgkmcnt(7)
    v_mfma_f32_32x32x16_bf16 v[16:31], v[136:139], v[104:107], v[16:31]
    v_exp_f32 v32, v32
    v_exp_f32 v33, v33
    v_exp_f32 v34, v34
    v_exp_f32 v35, v35
    v_mfma_f32_32x32x16_bf16 v[16:31], v[140:143], v[108:111], v[16:31]
    v_exp_f32 v36, v36
    v_exp_f32 v37, v37
    v_exp_f32 v38, v38
    v_exp_f32 v39, v39
    v_mfma_f32_32x32x16_bf16 v[48:63], v[120:123], v[152:155], v[80:95]
    v_exp_f32 v40, v40
    v_exp_f32 v41, v41
    v_exp_f32 v42, v42
    v_exp_f32 v43, v43
    v_mfma_f32_32x32x16_bf16 v[48:63], v[124:127], v[156:159], v[48:63]
    v_exp_f32 v44, v44
    v_exp_f32 v45, v45
    v_exp_f32 v46, v46
    v_exp_f32 v47, v47
    s_cmp_eq_u32 s38, 0
    s_cbranch_scc0 parallel_sum__sliding_block__dense_activation_gelu__prompt_kernel_a_A_mask
parallel_sum__sliding_block__dense_activation_gelu__prompt_kernel_a_A_back:
    v_cvt_pk_bf16_f32 v96, v32, v33
    v_cvt_pk_bf16_f32 v97, v34, v35
    v_cvt_pk_bf16_f32 v98, v36, v37
    v_cvt_pk_bf16_f32 v99, v38, v39
    v_cvt_pk_bf16_f32 v100, v40, v41
    v_cvt_pk_bf16_f32 v101, v42, v43
    v_cvt_pk_bf16_f32 v102, v44, v45
    v_cvt_pk_bf16_f32 v103, v46, v47
    ds_read_b64_tr_b16 v[136:137], v163 offset:0
    ds_read_b64_tr_b16 v[138:139], v163 offset:64
    ds_read_b64_tr_b16 v[140:141], v163 offset:128
    ds_read_b64_tr_b16 v[142:143], v163 offset:192
    ds_read_b64 v[120:121], v160 offset:18880
    ds_read_b64 v[122:123], v160 offset:21984
    ds_read_b64 v[124:125], v161 offset:256
    s_waitcnt lgkmcnt(7)
    v_mfma_f32_32x32x16_bf16 v[0:15], v[128:131], v[96:99], v[0:15]
    v_exp_f32 v48, v48
    v_exp_f32 v49, v49
    v_exp_f32 v50, v50
    v_exp_f32 v51, v51
    v_mfma_f32_32x32x16_bf16 v[0:15], v[132:135], v[100:103], v[0:15]
    v_exp_f32 v52, v52
    v_exp_f32 v53, v53
    v_exp_f32 v54, v54
    v_exp_f32 v55, v55
    v_mfma_f32_32x32x16_bf16 v[32:47], v[112:115], v[144:147], v[64:79]
    v_exp_f32 v56, v56
    v_exp_f32 v57, v57
    v_exp_f32 v58, v58
    v_exp_f32 v59, v59
    v_mfma_f32_32x32x16_bf16 v[32:47], v[116:119], v[148:151], v[32:47]
    v_exp_f32 v60, v60
    v_exp_f32 v61, v61
    v_exp_f32 v62, v62
    v_exp_f32 v63, v63
    s_cmp_eq_u32 s38, 0
    s_cbranch_scc0 parallel_sum__sliding_block__dense_activation_gelu__prompt_kernel_a_B_mask
parallel_sum__sliding_block__dense_activation_gelu__prompt_kernel_a_B_back:
    v_cvt_pk_bf16_f32 v104, v48, v49
    v_cvt_pk_bf16_f32 v105, v50, v51
    v_cvt_pk_bf16_f32 v106, v52, v53
    v_cvt_pk_bf16_f32 v107, v54, v55
    v_cvt_pk_bf16_f32 v108, v56, v57
    v_cvt_pk_bf16_f32 v109, v58, v59
    v_cvt_pk_bf16_f32 v110, v60, v61
    v_cvt_pk_bf16_f32 v111, v62, v63
    v_add_u32 v160, 256, v160
    v_add_u32 v161, 256, v161
    v_add_u32 v162, v190, v162
    v_add_u32 v163, v191, v163
    s_add_u32 s40, s40, 1
    s_cmp_eq_u32 s40, s42
    s_cselect_b32 s38, 1, 0
    s_cmp_eq_u32 s40, s41
    s_cselect_b32 s38, 1, s38
    s_cmp_le_u32 s40, s41
    s_cbranch_scc1 parallel_sum__sliding_block__dense_activation_gelu__prompt_kernel_a_loop
    s_waitcnt lgkmcnt(0)
    v_mfma_f32_32x32x16_bf16 v[16:31], v[136:139], v[104:107], v[16:31]
    v_mfma_f32_32x32x16_bf16 v[16:31], v[140:143], v[108:111], v[16:31]
    s_nop 7
    s_nop 7
    v_mov_b32 v172, v8
    v_mov_b32 v173, v8
    s_nop 1
    v_permlane32_swap_b32 v172, v173
    v_mov_b32 v174, v24
    v_mov_b32 v175, v24
    s_nop 1
    v_permlane32_swap_b32 v174, v175
    s_nop 1
    s_cmp_lg_u32 s43, 0
    s_cbranch_scc1 parallel_sum__sliding_block__dense_activation_gelu__prompt_kernel_a_fin
    s_mov_b32 s6, 0x21800000
    s_mov_b32 s7, 0x5d800000
    v_cmp_le_f32 s[32:33], s6, v173
    v_cmp_ge_f32 s[34:35], s7, v173
    s_and_b64 s[32:33], s[32:33], s[34:35]
    v_cmp_le_f32 s[34:35], s6, v174
    s_and_b64 s[32:33], s[32:33], s[34:35]
    v_cmp_ge_f32 s[34:35], s7, v174
    s_and_b64 s[32:33], s[32:33], s[34:35]
    s_cmp_eq_u64 s[32:33], -1
    s_cbranch_scc1 parallel_sum__sliding_block__dense_activation_gelu__prompt_kernel_a_fin
    s_branch parallel_sum__sliding_block__dense_activation_gelu__prompt_kernel_a_fallback
parallel_sum__sliding_block__dense_activation_gelu__prompt_kernel_a_A_mask:
    s_cmp_eq_u32 s40, s42
    s_cbranch_scc0 parallel_sum__sliding_block__dense_activation_gelu__prompt_kernel_a_A_nf
    v_cndmask_b32 v32, 0, v32, s[44:45]
    v_cndmask_b32 v33, 0, v33, s[46:47]
    v_cndmask_b32 v34, 0, v34, s[48:49]
    v_cndmask_b32 v35, 0, v35, s[50:51]
    v_cndmask_b32 v36, 0, v36, s[52:53]
    v_cndmask_b32 v37, 0, v37, s[54:55]
    v_cndmask_b32 v38, 0, v38, s[56:57]
    v_cndmask_b32 v39, 0, v39, s[58:59]
    v_cndmask_b32 v40, 0, v40, s[60:61]
    v_cndmask_b32 v41, 0, v41, s[62:63]
    v_cndmask_b32 v42, 0, v42, s[64:65]
    v_cndmask_b32 v43, 0, v43, s[66:67]
    v_cndmask_b32 v44, 0, v44, s[68:69]
    v_cndmask_b32 v45, 0, v45, s[70:71]
    v_cndmask_b32 v46, 0, v46, s[72:73]
    v_cndmask_b32 v47, 0, v47, s[74:75]
    s_branch parallel_sum__sliding_block__dense_activation_gelu__prompt_kernel_a_A_back
parallel_sum__sliding_block__dense_activation_gelu__prompt_kernel_a_A_nf:
    v_cndmask_b32 v32, v32, 0, s[44:45]
    v_cndmask_b32 v33, v33, 0, s[46:47]
    v_cndmask_b32 v34, v34, 0, s[48:49]
    v_cndmask_b32 v35, v35, 0, s[50:51]
    v_cndmask_b32 v36, v36, 0, s[52:53]
    v_cndmask_b32 v37, v37, 0, s[54:55]
    v_cndmask_b32 v38, v38, 0, s[56:57]
    v_cndmask_b32 v39, v39, 0, s[58:59]
    v_cndmask_b32 v40, v40, 0, s[60:61]
    v_cndmask_b32 v41, v41, 0, s[62:63]
    v_cndmask_b32 v42, v42, 0, s[64:65]
    v_cndmask_b32 v43, v43, 0, s[66:67]
    v_cndmask_b32 v44, v44, 0, s[68:69]
    v_cndmask_b32 v45, v45, 0, s[70:71]
    v_cndmask_b32 v46, v46, 0, s[72:73]
    v_cndmask_b32 v47, v47, 0, s[74:75]
    s_branch parallel_sum__sliding_block__dense_activation_gelu__prompt_kernel_a_A_back
parallel_sum__sliding_block__dense_activation_gelu__prompt_kernel_a_B_mask:
    s_cmp_eq_u32 s40, s42
    s_cbranch_scc0 parallel_sum__sliding_block__dense_activation_gelu__prompt_kernel_a_B_nf
    v_cndmask_b32 v48, 0, v48, s[44:45]
    v_cndmask_b32 v49, 0, v49, s[46:47]
    v_cndmask_b32 v50, 0, v50, s[48:49]
    v_cndmask_b32 v51, 0, v51, s[50:51]
    v_cndmask_b32 v52, 0, v52, s[52:53]
    v_cndmask_b32 v53, 0, v53, s[54:55]
    v_cndmask_b32 v54, 0, v54, s[56:57]
    v_cndmask_b32 v55, 0, v55, s[58:59]
    v_cndmask_b32 v56, 0, v56, s[60:61]
    v_cndmask_b32 v57, 0, v57, s[62:63]
    v_cndmask_b32 v58, 0, v58, s[64:65]
    v_cndmask_b32 v59, 0, v59, s[66:67]
    v_cndmask_b32 v60, 0, v60, s[68:69]
    v_cndmask_b32 v61, 0, v61, s[70:71]
    v_cndmask_b32 v62, 0, v62, s[72:73]
    v_cndmask_b32 v63, 0, v63, s[74:75]
    s_branch parallel_sum__sliding_block__dense_activation_gelu__prompt_kernel_a_B_back
parallel_sum__sliding_block__dense_activation_gelu__prompt_kernel_a_B_nf:
    v_cndmask_b32 v48, v48, 0, s[44:45]
    v_cndmask_b32 v49, v49, 0, s[46:47]
    v_cndmask_b32 v50, v50, 0, s[48:49]
    v_cndmask_b32 v51, v51, 0, s[50:51]
    v_cndmask_b32 v52, v52, 0, s[52:53]
    v_cndmask_b32 v53, v53, 0, s[54:55]
    v_cndmask_b32 v54, v54, 0, s[56:57]
    v_cndmask_b32 v55, v55, 0, s[58:59]
    v_cndmask_b32 v56, v56, 0, s[60:61]
    v_cndmask_b32 v57, v57, 0, s[62:63]
    v_cndmask_b32 v58, v58, 0, s[64:65]
    v_cndmask_b32 v59, v59, 0, s[66:67]
    v_cndmask_b32 v60, v60, 0, s[68:69]
    v_cndmask_b32 v61, v61, 0, s[70:71]
    v_cndmask_b32 v62, v62, 0, s[72:73]
    v_cndmask_b32 v63, v63, 0, s[74:75]
    s_branch parallel_sum__sliding_block__dense_activation_gelu__prompt_kernel_a_B_back
parallel_sum__sliding_block__dense_activation_gelu__prompt_kernel_a_fallback:
    s_mov_b32 s43, 1
    s_sub_u32 s6, s41, s39
    s_add_u32 s6, s6, 1
    v_mul_u32_u24 v178, s6, v190
    v_sub_u32 v162, v162, v178
    v_mul_u32_u24 v178, s6, v191
    v_sub_u32 v163, v163, v178
    s_lshl_b32 s6, s6, 8
    v_subrev_u32 v160, s6, v160
    v_subrev_u32 v161, s6, v161
    v_mov_b32 v176, 0xff800000
    v_mov_b32 v177, 0xff800000
    v_mov_b32 v178, v160
    v_mov_b32 v179, v161
    s_mov_b32 s40, s39
    v_mov_b32 v180, 0xff800000
parallel_sum__sliding_block__dense_activation_gelu__prompt_kernel_a_mloop:
    ds_read_b64 v[112:113], v178
    ds_read_b64 v[114:115], v178 offset:3104
    ds_read_b64 v[116:117], v179
    ds_read_b64 v[120:121], v178 offset:18624
    ds_read_b64 v[122:123], v178 offset:21728
    s_waitcnt lgkmcnt(0)
    v_mfma_f32_32x32x16_bf16 v[32:47], v[112:115], v[144:147], 0
    v_mfma_f32_32x32x16_bf16 v[32:47], v[116:119], v[148:151], v[32:47]
    v_mfma_f32_32x32x16_bf16 v[48:63], v[120:123], v[152:155], 0
    v_mfma_f32_32x32x16_bf16 v[48:63], v[116:119], v[156:159], v[48:63]
    s_nop 7
    s_nop 7
    s_cmp_eq_u32 s40, s42
    s_cbranch_scc0 parallel_sum__sliding_block__dense_activation_gelu__prompt_kernel_a_m_nf
    v_cndmask_b32 v32, v180, v32, s[44:45]
    v_cndmask_b32 v33, v180, v33, s[46:47]
    v_cndmask_b32 v34, v180, v34, s[48:49]
    v_cndmask_b32 v35, v180, v35, s[50:51]
    v_cndmask_b32 v36, v180, v36, s[52:53]
    v_cndmask_b32 v37, v180, v37, s[54:55]
    v_cndmask_b32 v38, v180, v38, s[56:57]
    v_cndmask_b32 v39, v180, v39, s[58:59]
    v_cndmask_b32 v40, v180, v40, s[60:61]
    v_cndmask_b32 v41, v180, v41, s[62:63]
    v_cndmask_b32 v42, v180, v42, s[64:65]
    v_cndmask_b32 v43, v180, v43, s[66:67]
    v_cndmask_b32 v44, v180, v44, s[68:69]
    v_cndmask_b32 v45, v180, v45, s[70:71]
    v_cndmask_b32 v46, v180, v46, s[72:73]
    v_cndmask_b32 v47, v180, v47, s[74:75]
    v_cndmask_b32 v48, v180, v48, s[44:45]
    v_cndmask_b32 v49, v180, v49, s[46:47]
    v_cndmask_b32 v50, v180, v50, s[48:49]
    v_cndmask_b32 v51, v180, v51, s[50:51]
    v_cndmask_b32 v52, v180, v52, s[52:53]
    v_cndmask_b32 v53, v180, v53, s[54:55]
    v_cndmask_b32 v54, v180, v54, s[56:57]
    v_cndmask_b32 v55, v180, v55, s[58:59]
    v_cndmask_b32 v56, v180, v56, s[60:61]
    v_cndmask_b32 v57, v180, v57, s[62:63]
    v_cndmask_b32 v58, v180, v58, s[64:65]
    v_cndmask_b32 v59, v180, v59, s[66:67]
    v_cndmask_b32 v60, v180, v60, s[68:69]
    v_cndmask_b32 v61, v180, v61, s[70:71]
    v_cndmask_b32 v62, v180, v62, s[72:73]
    v_cndmask_b32 v63, v180, v63, s[74:75]
parallel_sum__sliding_block__dense_activation_gelu__prompt_kernel_a_m_nf:
    s_cmp_eq_u32 s40, s41
    s_cbranch_scc0 parallel_sum__sliding_block__dense_activation_gelu__prompt_kernel_a_m_nl
    v_cndmask_b32 v32, v32, v180, s[44:45]
    v_cndmask_b32 v33, v33, v180, s[46:47]
    v_cndmask_b32 v34, v34, v180, s[48:49]
    v_cndmask_b32 v35, v35, v180, s[50:51]
    v_cndmask_b32 v36, v36, v180, s[52:53]
    v_cndmask_b32 v37, v37, v180, s[54:55]
    v_cndmask_b32 v38, v38, v180, s[56:57]
    v_cndmask_b32 v39, v39, v180, s[58:59]
    v_cndmask_b32 v40, v40, v180, s[60:61]
    v_cndmask_b32 v41, v41, v180, s[62:63]
    v_cndmask_b32 v42, v42, v180, s[64:65]
    v_cndmask_b32 v43, v43, v180, s[66:67]
    v_cndmask_b32 v44, v44, v180, s[68:69]
    v_cndmask_b32 v45, v45, v180, s[70:71]
    v_cndmask_b32 v46, v46, v180, s[72:73]
    v_cndmask_b32 v47, v47, v180, s[74:75]
    v_cndmask_b32 v48, v48, v180, s[44:45]
    v_cndmask_b32 v49, v49, v180, s[46:47]
    v_cndmask_b32 v50, v50, v180, s[48:49]
    v_cndmask_b32 v51, v51, v180, s[50:51]
    v_cndmask_b32 v52, v52, v180, s[52:53]
    v_cndmask_b32 v53, v53, v180, s[54:55]
    v_cndmask_b32 v54, v54, v180, s[56:57]
    v_cndmask_b32 v55, v55, v180, s[58:59]
    v_cndmask_b32 v56, v56, v180, s[60:61]
    v_cndmask_b32 v57, v57, v180, s[62:63]
    v_cndmask_b32 v58, v58, v180, s[64:65]
    v_cndmask_b32 v59, v59, v180, s[66:67]
    v_cndmask_b32 v60, v60, v180, s[68:69]
    v_cndmask_b32 v61, v61, v180, s[70:71]
    v_cndmask_b32 v62, v62, v180, s[72:73]
    v_cndmask_b32 v63, v63, v180, s[74:75]
parallel_sum__sliding_block__dense_activation_gelu__prompt_kernel_a_m_nl:
    v_max_f32 v176, v176, v32
    v_max_f32 v177, v177, v48
    v_max_f32 v176, v176, v33
    v_max_f32 v177, v177, v49
    v_max_f32 v176, v176, v34
    v_max_f32 v177, v177, v50
    v_max_f32 v176, v176, v35
    v_max_f32 v177, v177, v51
    v_max_f32 v176, v176, v36
    v_max_f32 v177, v177, v52
    v_max_f32 v176, v176, v37
    v_max_f32 v177, v177, v53
    v_max_f32 v176, v176, v38
    v_max_f32 v177, v177, v54
    v_max_f32 v176, v176, v39
    v_max_f32 v177, v177, v55
    v_max_f32 v176, v176, v40
    v_max_f32 v177, v177, v56
    v_max_f32 v176, v176, v41
    v_max_f32 v177, v177, v57
    v_max_f32 v176, v176, v42
    v_max_f32 v177, v177, v58
    v_max_f32 v176, v176, v43
    v_max_f32 v177, v177, v59
    v_max_f32 v176, v176, v44
    v_max_f32 v177, v177, v60
    v_max_f32 v176, v176, v45
    v_max_f32 v177, v177, v61
    v_max_f32 v176, v176, v46
    v_max_f32 v177, v177, v62
    v_max_f32 v176, v176, v47
    v_max_f32 v177, v177, v63
    v_add_u32 v178, 256, v178
    v_add_u32 v179, 256, v179
    s_add_u32 s40, s40, 1
    s_cmp_le_u32 s40, s41
    s_cbranch_scc1 parallel_sum__sliding_block__dense_activation_gelu__prompt_kernel_a_mloop
    v_mov_b32 v178, v176
    s_nop 1
    v_permlane32_swap_b32 v178, v176
    s_nop 1
    v_max_f32 v176, v176, v178
    v_sub_f32 v176, 0, v176
    v_mov_b32 v64, v176
    v_mov_b32 v65, v176
    v_mov_b32 v66, v176
    v_mov_b32 v67, v176
    v_mov_b32 v68, v176
    v_mov_b32 v69, v176
    v_mov_b32 v70, v176
    v_mov_b32 v71, v176
    v_mov_b32 v72, v176
    v_mov_b32 v73, v176
    v_mov_b32 v74, v176
    v_mov_b32 v75, v176
    v_mov_b32 v76, v176
    v_mov_b32 v77, v176
    v_mov_b32 v78, v176
    v_mov_b32 v79, v176
    v_mov_b32 v178, v177
    s_nop 1
    v_permlane32_swap_b32 v178, v177
    s_nop 1
    v_max_f32 v177, v177, v178
    v_sub_f32 v177, 0, v177
    v_mov_b32 v80, v177
    v_mov_b32 v81, v177
    v_mov_b32 v82, v177
    v_mov_b32 v83, v177
    v_mov_b32 v84, v177
    v_mov_b32 v85, v177
    v_mov_b32 v86, v177
    v_mov_b32 v87, v177
    v_mov_b32 v88, v177
    v_mov_b32 v89, v177
    v_mov_b32 v90, v177
    v_mov_b32 v91, v177
    v_mov_b32 v92, v177
    v_mov_b32 v93, v177
    v_mov_b32 v94, v177
    v_mov_b32 v95, v177
    s_branch parallel_sum__sliding_block__dense_activation_gelu__prompt_kernel_a_restart
parallel_sum__sliding_block__dense_activation_gelu__prompt_kernel_a_fin:
    v_rcp_f32 v172, v173
    v_rcp_f32 v174, v174
    s_lshl_b32 s6, s4, 2
    s_add_u32 s6, s6, s3
    s_mul_i32 s6, s6, 139264
    s_mul_i32 s7, s5, 2560
    s_add_u32 s6, s6, s7
    s_add_u32 s6, s6, 0
    v_lshlrev_b32 v178, 4, v164
    v_lshl_add_u32 v179, v165, 9, v178
    v_mul_f32 v0, v0, v172
    v_mul_f32 v1, v1, v172
    v_mul_f32 v2, v2, v172
    v_mul_f32 v3, v3, v172
    v_cvt_pk_bf16_f32 v96, v0, v1
    v_cvt_pk_bf16_f32 v97, v2, v3
    v_mul_f32 v4, v4, v172
    v_mul_f32 v5, v5, v172
    v_mul_f32 v6, v6, v172
    v_mul_f32 v7, v7, v172
    v_cvt_pk_bf16_f32 v98, v4, v5
    v_cvt_pk_bf16_f32 v99, v6, v7
    v_mul_f32 v8, v8, v172
    v_mul_f32 v9, v9, v172
    v_mul_f32 v10, v10, v172
    v_mul_f32 v11, v11, v172
    v_cvt_pk_bf16_f32 v104, v8, v9
    v_cvt_pk_bf16_f32 v105, v10, v11
    v_mul_f32 v16, v16, v174
    v_mul_f32 v17, v17, v174
    v_mul_f32 v18, v18, v174
    v_mul_f32 v19, v19, v174
    v_cvt_pk_bf16_f32 v100, v16, v17
    v_cvt_pk_bf16_f32 v101, v18, v19
    v_mul_f32 v20, v20, v174
    v_mul_f32 v21, v21, v174
    v_mul_f32 v22, v22, v174
    v_mul_f32 v23, v23, v174
    v_cvt_pk_bf16_f32 v102, v20, v21
    v_cvt_pk_bf16_f32 v103, v22, v23
    v_mul_f32 v24, v24, v174
    v_mul_f32 v25, v25, v174
    v_mul_f32 v26, v26, v174
    v_mul_f32 v27, v27, v174
    v_cvt_pk_bf16_f32 v108, v24, v25
    v_cvt_pk_bf16_f32 v109, v26, v27
    s_nop 1
    v_permlane32_swap_b32 v96, v98
    v_permlane32_swap_b32 v97, v99
    v_permlane32_swap_b32 v100, v102
    v_permlane32_swap_b32 v101, v103
    v_permlane32_swap_b32 v108, v106
    v_permlane32_swap_b32 v109, v107
    s_nop 1
    buffer_store_dwordx4 v[96:99], v179, s[20:23], s6 offen sc1
    buffer_store_dwordx4 v[100:103], v179, s[20:23], s6 offen offset:1536 sc1
    s_mov_b64 exec, 0xffffffff
    buffer_store_dwordx4 v[104:107], v178, s[20:23], s6 offen offset:1024 sc1
    s_mov_b64 exec, -1
    s_lshl_b32 s95, s4, 4
    s_add_u32 s95, s95, s5
    s_lshl_b32 s95, s95, 7
    s_add_u32 s95, s95, 18481152
    s_waitcnt vmcnt(0)
    v_mov_b32 v212, 163484
    v_mov_b32 v213, 1
    s_mov_b64 exec, 1
    ds_add_rtn_u32 v214, v212, v213
    s_waitcnt lgkmcnt(0)
    v_readfirstlane_b32 s32, v214
    s_cmp_eq_u32 s32, 3
    s_cbranch_scc0 parallel_sum__sliding_block__dense_activation_gelu__prompt_kernel_po
    v_mov_b32 v212, 0
    v_mov_b32 v213, s94
    buffer_store_dword v213, v212, s[20:23], s95 offen offset:0 sc1
parallel_sum__sliding_block__dense_activation_gelu__prompt_kernel_po:
    s_mov_b64 exec, -1
    s_and_b32 s6, s2, 7
    s_lshr_b32 s7, s2, 3
    s_lshr_b32 s38, s6, 1
    s_and_b32 s39, s6, 1
    s_mul_i32 s5, s7, 52
    s_lshr_b32 s4, s5, 8
    s_mul_i32 s5, s4, 5
    s_sub_u32 s5, s7, s5
    s_mul_i32 s39, s39, 5
    s_add_u32 s5, s5, s39
    s_and_b32 s39, s38, 1
    s_sub_u32 s39, 6, s39
    s_cmp_ge_u32 s4, s39
    s_cselect_b32 s46, 1, 0
    s_mul_i32 s39, s38, 11
    s_add_u32 s39, s39, 1
    s_lshr_b32 s39, s39, 1
    s_add_u32 s4, s4, s39
    s_cmp_lg_u32 s46, 0
    s_cbranch_scc1 parallel_sum__sliding_block__dense_activation_gelu__prompt_kernel_end
    s_barrier
parallel_sum__sliding_block__dense_activation_gelu__prompt_kernel_end:
    s_endpgm
.section .rodata,"a"
.p2align 6
.amdhsa_kernel parallel_sum__sliding_block__dense_activation_gelu__prompt_kernel
  .amdhsa_next_free_vgpr 256
  .amdhsa_next_free_sgpr 102
  .amdhsa_accum_offset 256
  .amdhsa_group_segment_fixed_size 0
  .amdhsa_kernarg_size 88
  .amdhsa_user_sgpr_count 2
  .amdhsa_user_sgpr_kernarg_segment_ptr 1
  .amdhsa_system_sgpr_workgroup_id_x 1
.end_amdhsa_kernel
```
